```python
import torch

def _softmax(x, axis=-1):
    return torch.softmax(x, dim=axis)

def _gelu(x):
    return torch.nn.functional.gelu(x, approximate='tanh')

def _silu(x):
    return torch.nn.functional.silu(x)

def _sigmoid(x):
    return torch.sigmoid(x)

def _layernorm(x, axis=-1, eps=1e-05):
    m = x.mean(dim=axis, keepdim=True)
    v = x.var(dim=axis, keepdim=True, unbiased=False)
    return (x - m) / torch.sqrt(v + eps)

def _scatter_add(tgt, idx, src, axis=0):
    return tgt.clone().index_add_(axis, idx, src)

def _segment_sum(src, seg, n):
    out = torch.zeros((n,) + src.shape[1:], dtype=src.dtype)
    return out.index_add_(0, seg, src)

def _pad(x, pw):
    flat = tuple((v for pair in reversed(pw) for v in pair))
    return torch.nn.functional.pad(x, flat)
kernel_name = 'gather_scatter__tensor_product_equiv_equiformer__graph'

def setup_inputs():

    _w = lambda a: (lambda t: t.to(torch.bfloat16) if t.is_floating_point() else t)(torch.as_tensor(a))
    N, deg, C, De = (12500, 64, 64, max(4, 1))
    E = N * deg
    src = (lambda lo, hi, *s: torch.randint(lo, hi, s))(0, N, E).to(torch.int64)
    dst = (lambda lo, hi, *s: torch.randint(lo, hi, s))(0, N, E).to(torch.int64)
    rvec = (lambda *s: torch.randn(*s, dtype=torch.bfloat16) * 0.05)(E, 3).to(float)
    rn = (torch.linalg.norm(rvec, dim=-1, keepdim=True) + 1e-06).to(float)
    rhat = (rvec / rn).to(float)
    eps = torch.zeros((3, 3, 3), dtype=float)
    eps[0, 1, 2] = eps[1, 2, 0] = eps[2, 0, 1] = 1.0
    eps[0, 2, 1] = eps[2, 1, 0] = eps[1, 0, 2] = -1.0
    return {'x': _w((lambda *s: torch.randn(*s, dtype=torch.bfloat16) * 0.4)(N, 4 * C).to(float)), 'rhat': _w(rhat), 'e_attr': _w((lambda *s: torch.randn(*s, dtype=torch.bfloat16) * 0.4)(E, De).to(float)), 'src': _w(src), 'dst': _w(dst), 'w_rad': _w((lambda *s: torch.randn(*s, dtype=torch.bfloat16) * 0.4)(De, 5 * C).to(float)), 'w_si0': _w((lambda *s: torch.randn(*s, dtype=torch.bfloat16) * 0.4)(2 * C, C).to(float)), 'w_si1': _w((lambda *s: torch.randn(*s, dtype=torch.bfloat16) * 0.05)(3 * C, C).to(float)), 'cg_eps': _w(eps)}

def reference(x, rhat, e_attr, src, dst, w_rad, w_si0, w_si1, cg_eps):
    N = x.shape[0]
    C = w_si0.shape[1]
    E = rhat.shape[0]
    x0 = x[:, :C].clone()
    x1 = x[:, C:].reshape(N, 3, C)
    R = (e_attr @ w_rad).reshape(E, 5, C)
    f0 = x0[src]
    f1 = x1[src]
    Y1 = rhat
    p00_0 = f0 * R[:, 0, :]
    p11_0 = torch.einsum('ejc,ej->ec', f1, Y1) * R[:, 1, :]
    p01_1 = torch.einsum('ec,ej->ejc', f0, Y1) * R[:, 2, :][:, None, :]
    p10_1 = f1 * R[:, 3, :][:, None, :]
    p11_1 = torch.einsum('ijk,ekc,ej->eic', cg_eps, f1, Y1) * R[:, 4, :][:, None, :]
    m0 = torch.concatenate([p00_0, p11_0], axis=-1) @ w_si0
    m1 = torch.einsum('ejp,pc->ejc', torch.concatenate([p01_1, p10_1, p11_1], axis=-1), w_si1)
    agg0 = _segment_sum(m0, dst, N)
    agg1 = _segment_sum(m1.reshape(E, 3 * C), dst, N).reshape(N, 3, C)
    gate = _sigmoid(agg0)
    out1 = agg1 * gate[:, None, :]
    return torch.concatenate([agg0, out1.reshape(N, 3 * C)], axis=-1)
```

```asm
; @launch grid=(250,1,1) block=(1024,1,1) lds=160768
.amdgcn_target "amdgcn-amd-amdhsa--gfx950"
.text
.globl gather_scatter__tensor_product_equiv_equiformer__graph_kernel
.p2align 8
.type gather_scatter__tensor_product_equiv_equiformer__graph_kernel,@function
gather_scatter__tensor_product_equiv_equiformer__graph_kernel:
    s_cmp_ge_u32 s2, 250
    s_cbranch_scc1 L_end
    s_load_dwordx8 s[32:39], s[0:1], 0
    s_load_dwordx8 s[40:47], s[0:1], 32
    s_movk_i32 s51, 800
    s_mul_i32 s48, s2, 1600
    v_add_u32 v3, s48, v0
    v_cmp_gt_u32 vcc, s51, v0
    v_lshlrev_b32 v28, 3, v3
    v_lshlrev_b32 v30, 4, v3
    v_mul_u32_u24 v3, 12, v3
    v_add_u32 v29, 6400, v28
    v_add_u32 v31, 12800, v30
    v_add_u32 v27, 9600, v3
    s_and_saveexec_b64 s[26:27], vcc
    s_cbranch_execz L1_noload
    s_waitcnt lgkmcnt(0)
    global_load_dwordx2 v[4:5], v28, s[40:41] nt
    global_load_dwordx2 v[6:7], v29, s[40:41] nt
L1_noload:
    s_mov_b64 exec, -1
    s_load_dwordx4 s[80:83], s[0:1], 72
    s_load_dwordx2 s[84:85], s[0:1], 88
    v_lshlrev_b32 v1, 4, v0
    v_lshlrev_b32 v2, 5, v0
    v_readfirstlane_b32 s21, v0
    s_lshr_b32 s21, s21, 6
    s_waitcnt lgkmcnt(0)
    s_mov_b32 s4, s32
    s_mov_b32 s5, s33
    s_mov_b32 s6, 6400000
    s_mov_b32 s7, 0x20000
    s_mov_b32 s8, s84
    s_mov_b32 s9, s85
    s_mov_b32 s10, 17696000
    s_mov_b32 s11, 0x20000
    s_mov_b32 s12, s80
    s_mov_b32 s13, s81
    s_mov_b32 s14, 6400000
    s_mov_b32 s15, 0x20000
    s_mov_b32 s16, s42
    s_mov_b32 s17, s43
    s_mov_b32 s18, 2560
    s_mov_b32 s19, 0x20000
    s_mov_b32 s68, s44
    s_mov_b32 s69, s45
    s_mov_b32 s70, 16384
    s_mov_b32 s71, 0x20000
    s_mov_b32 s72, s46
    s_mov_b32 s73, s47
    s_mov_b32 s74, 24576
    s_mov_b32 s75, 0x20000
    s_mov_b32 s76, s82
    s_mov_b32 s77, s83
    s_mov_b32 s78, 256
    s_mov_b32 s79, 0x20000
    s_and_b32 s20, s2, 7
    s_lshr_b32 s31, s2, 3
    s_min_u32 s22, s20, 2
    s_mul_i32 s20, s20, 31
    s_add_u32 s20, s20, s22
    s_add_u32 s20, s20, s31
    s_mov_b32 s22, 0
    s_movk_i32 s23, 250
    s_mov_b32 s24, 1
    s_mov_b32 s26, 0xaaaaaaaa
    s_mov_b32 s27, 0xaaaaaaaa
    s_mov_b32 s28, 0x05040100
    s_mov_b32 s29, 0x07060302
    s_mov_b32 s30, 0xffff0000
    s_mul_i32 s51, s2, 70784
    s_cmp_ge_u32 s21, 13
    s_cbranch_scc1 L1_aux
    s_mov_b32 s46, 115968
    v_lshl_add_u32 v40, v0, 2, s46
    v_mov_b32 v41, 0
    v_mov_b32 v42, 1
    s_movk_i32 s49, 2176
    s_mov_b32 s50, 0x05040302
    s_mov_b32 s45, 4294171912
    s_mov_b32 s48, -25
    s_movk_i32 s47, 249
    s_cmp_ge_u32 s21, 8
    s_cbranch_scc1 L1_nz
    ds_write_b32 v40, v41
    s_waitcnt lgkmcnt(0)
L1_nz:
    s_barrier
    s_and_b64 exec, exec, vcc
    global_load_dwordx2 v[8:9], v28, s[38:39] nt
    global_load_dwordx2 v[10:11], v29, s[38:39] nt
    global_load_dwordx4 v[12:15], v30, s[36:37] nt
    global_load_dwordx4 v[16:19], v31, s[36:37] nt
    global_load_dwordx3 v[20:22], v3, s[34:35] nt
    global_load_dwordx3 v[24:26], v27, s[34:35] nt
    s_waitcnt vmcnt(6)
    v_mul_u32_u24 v44, 0x147b, v4
    v_mul_u32_u24 v45, 0x147b, v5
    v_mul_u32_u24 v46, 0x147b, v6
    v_mul_u32_u24 v47, 0x147b, v7
    v_lshrrev_b32 v44, 17, v44
    v_lshrrev_b32 v45, 17, v45
    v_lshrrev_b32 v46, 17, v46
    v_lshrrev_b32 v47, 17, v47
    v_cmp_lt_u32 s[32:33], s47, v44
    v_cmp_lt_u32 s[34:35], s47, v45
    v_cmp_lt_u32 s[36:37], s47, v46
    v_cmp_lt_u32 s[38:39], s47, v47
    v_cndmask_b32 v36, 0, 1, s[32:33]
    v_cndmask_b32 v37, 0, 1, s[34:35]
    v_cndmask_b32 v38, 0, 1, s[36:37]
    v_cndmask_b32 v39, 0, 1, s[38:39]
    v_sub_u32 v48, v44, v36
    v_mad_u32_u24 v44, v36, 6, v44
    v_sub_u32 v49, v45, v37
    v_mad_u32_u24 v45, v37, 6, v45
    v_sub_u32 v50, v46, v38
    v_mad_u32_u24 v46, v38, 6, v46
    v_sub_u32 v51, v47, v39
    v_mad_u32_u24 v47, v39, 6, v47
    v_mad_i32_i24 v4, v48, s48, v4
    v_lshl_add_u32 v44, v44, 2, s46
    v_mad_i32_i24 v5, v49, s48, v5
    v_lshl_add_u32 v45, v45, 2, s46
    v_mad_i32_i24 v6, v50, s48, v6
    v_lshl_add_u32 v46, v46, 2, s46
    v_mad_i32_i24 v7, v51, s48, v7
    v_lshl_add_u32 v47, v47, 2, s46
    ds_add_rtn_u32 v36, v44, v42
    ds_add_rtn_u32 v37, v45, v42
    ds_add_rtn_u32 v38, v46, v42
    ds_add_rtn_u32 v39, v47, v42
    v_lshl_add_u32 v48, v44, 3, s45
    v_lshl_add_u32 v49, v45, 3, s45
    v_lshl_add_u32 v50, v46, 3, s45
    v_lshl_add_u32 v51, v47, 3, s45
    v_lshlrev_b32 v4, 2, v4
    v_lshlrev_b32 v5, 2, v5
    v_lshlrev_b32 v6, 2, v6
    v_lshlrev_b32 v7, 2, v7
    s_waitcnt lgkmcnt(0)
    s_barrier
    v_min_u32 v28, 20, v36
    v_min_u32 v29, 20, v37
    v_min_u32 v30, 20, v38
    v_min_u32 v31, 20, v39
    v_add_u32 v48, v48, v28
    v_add_u32 v49, v49, v29
    v_add_u32 v50, v50, v30
    v_add_u32 v51, v51, v31
    s_cmp_eq_u32 s21, 0
    s_cbranch_scc1 L1_scan
    ds_write_b8 v48, v4
    ds_write_b8 v49, v5
    ds_write_b8 v50, v6
    ds_write_b8 v51, v7
    s_branch L1_noscan
L1_scan:
    v_add_u32 v60, s46, v2
    ds_read_b128 v[52:55], v60
    ds_read_b128 v[56:59], v60 offset:16
    s_waitcnt lgkmcnt(0)
    v_mov_b32 v64, 0
    v_mov_b32 v65, v52
    v_add_u32 v66, v65, v53
    v_add_u32 v67, v66, v54
    v_add_u32 v68, v67, v55
    v_add_u32 v69, v68, v56
    v_add_u32 v70, v69, v57
    v_add_u32 v71, v70, v58
    v_add_u32 v61, v71, v59
    v_max3_u32 v63, v52, v53, v54
    v_max3_u32 v63, v63, v55, v56
    v_max3_u32 v63, v63, v57, v58
    v_max_u32 v63, v63, v59
    v_cmp_lt_u32 s[42:43], 20, v63
    v_mov_b32 v62, v61
    s_nop 1
    v_add_u32_dpp v62, v62, v62 row_shr:1 row_mask:0xf bank_mask:0xf
    s_nop 1
    v_add_u32_dpp v62, v62, v62 row_shr:2 row_mask:0xf bank_mask:0xf
    s_nop 1
    v_add_u32_dpp v62, v62, v62 row_shr:4 row_mask:0xf bank_mask:0xf
    s_nop 1
    v_add_u32_dpp v62, v62, v62 row_shr:8 row_mask:0xf bank_mask:0xf
    s_nop 1
    v_add_u32_dpp v62, v62, v62 row_bcast:15 row_mask:0xa bank_mask:0xf
    s_nop 1
    v_add_u32_dpp v62, v62, v62 row_bcast:31 row_mask:0xc bank_mask:0xf
    v_sub_u32 v62, v62, v61
    v_add_u32 v64, v64, v62
    v_add_u32 v65, v65, v62
    v_add_u32 v66, v66, v62
    v_add_u32 v67, v67, v62
    v_add_u32 v68, v68, v62
    v_add_u32 v69, v69, v62
    v_add_u32 v70, v70, v62
    v_add_u32 v71, v71, v62
    ds_write_b128 v60, v[64:67] offset:2048
    ds_write_b128 v60, v[68:71] offset:2064
    s_cmp_lg_u64 s[42:43], 0
    s_cselect_b32 s42, 1, 0
    v_mov_b32 v63, s42
    ds_write_b32 v41, v63 offset:2056
    ds_write_b8 v48, v4
    ds_write_b8 v49, v5
    ds_write_b8 v50, v6
    ds_write_b8 v51, v7
    s_waitcnt lgkmcnt(4)
L1_noscan:
    s_barrier
    ds_read_b32 v44, v44 offset:2048
    ds_read_b32 v45, v45 offset:2048
    ds_read_b32 v46, v46 offset:2048
    ds_read_b32 v47, v47 offset:2048
    ds_read_b32 v28, v41 offset:2056
    s_waitcnt lgkmcnt(0)
    v_readfirstlane_b32 s42, v28
    v_add_u32 v36, v36, v44
    v_lshl_add_u32 v44, v36, 4, s49
    v_add_u32 v37, v37, v45
    v_lshl_add_u32 v45, v37, 4, s49
    v_add_u32 v38, v38, v46
    v_lshl_add_u32 v46, v38, 4, s49
    v_add_u32 v39, v39, v47
    v_lshl_add_u32 v47, v39, 4, s49
    s_cmp_eq_u32 s42, 0
    s_cbranch_scc1 L1_nokeys
    ds_write_b8 v36, v4 offset:53376
    ds_write_b8 v37, v5 offset:53376
    ds_write_b8 v38, v6 offset:53376
    ds_write_b8 v39, v7 offset:53376
L1_nokeys:
    s_waitcnt vmcnt(1)
    v_mov_b32 v28, v20
    v_perm_b32 v29, v8, v21, s28
    ds_write2_b64 v44, v[12:13], v[28:29] offset0:0 offset1:1
    v_alignbit_b32 v30, v22, v21, 16
    v_perm_b32 v31, v9, v22, s50
    ds_write2_b64 v45, v[14:15], v[30:31] offset0:0 offset1:1
    s_waitcnt vmcnt(0)
    v_mov_b32 v32, v24
    v_perm_b32 v33, v10, v25, s28
    ds_write2_b64 v46, v[16:17], v[32:33] offset0:0 offset1:1
    v_alignbit_b32 v34, v26, v25, 16
    v_perm_b32 v35, v11, v26, s50
    ds_write2_b64 v47, v[18:19], v[34:35] offset0:0 offset1:1
    s_mov_b64 exec, -1
    s_waitcnt lgkmcnt(0)
    s_branch L1_copy
L1_aux:
    v_subrev_u32 v64, 832, v0
    v_lshlrev_b32 v65, 4, v64
    s_mul_i32 s46, s31, 782
    s_mov_b32 s47, 96
    v_add_u32 v60, 0, v64
    v_cmp_gt_u32 vcc, s47, v60
    v_add_u32 v60, s46, v60
    v_and_b32 v61, 1, v60
    v_lshrrev_b32 v60, 1, v60
    v_lshlrev_b32 v60, 9, v60
    v_lshl_add_u32 v60, v61, 7, v60
    v_cndmask_b32 v60, 2.0, v60, vcc
    buffer_load_dword v62, v60, s[4:7], 0 offen offset:0
    s_getpc_b64 s[40:41]
L_cpf:
    s_mul_i32 s42, s31, 3
    s_add_u32 s42, s42, s21
    s_sub_u32 s42, s42, 13
    s_lshl_b32 s42, s42, 8
    s_min_u32 s43, s42, L_codeend-L_cpf-4
    s_load_dword s94, s[40:41], s43
    s_add_u32 s42, s42, 64
    s_min_u32 s43, s42, L_codeend-L_cpf-4
    s_load_dword s95, s[40:41], s43
    s_add_u32 s42, s42, 64
    s_min_u32 s43, s42, L_codeend-L_cpf-4
    s_load_dword s94, s[40:41], s43
    s_add_u32 s42, s42, 64
    s_min_u32 s43, s42, L_codeend-L_cpf-4
    s_load_dword s95, s[40:41], s43
    s_cmp_lg_u32 s21, 15
    s_cbranch_scc1 L1_notag
    s_cmp_lg_u32 s2, 0
    s_cbranch_scc1 L1_notag
    s_memrealtime s[44:45]
    s_waitcnt lgkmcnt(0)
    s_and_b32 s45, s45, 0x7f
    s_or_b32 s45, s45, 0x80
    s_lshl_b32 s45, s45, 24
    v_mov_b32 v68, s44
    v_mov_b32 v69, s45
    s_mov_b64 exec, 1
    buffer_store_dwordx2 v[68:69], off, s[76:79], 0 sc1
    s_mov_b64 exec, -1
L1_notag:
    s_cmp_lg_u32 s21, 13
    s_cbranch_scc1 L1_nozero
    v_mov_b32 v4, 0
    v_mov_b32 v5, 0
    v_mov_b32 v6, 0
    v_mov_b32 v7, 0
    ds_write_b128 v65, v[4:7]
    ds_write_b128 v65, v[4:7] offset:1024
L1_nozero:
    s_barrier
    s_barrier
    s_barrier
    s_cmp_lg_u32 s21, 15
    s_cbranch_scc1 L1_notag2
    s_mov_b32 s44, 0
L1_tagpoll:
    buffer_load_dwordx2 v[68:69], off, s[76:79], 0 sc1
    s_add_u32 s44, s44, 1
    s_waitcnt vmcnt(0)
    v_readfirstlane_b32 s45, v69
    s_nop 0
    s_cmp_lg_u32 s45, 0
    s_cbranch_scc1 L1_tagok
    s_cmp_lt_u32 s44, 0x100000
    s_cbranch_scc1 L1_tagpoll
L1_tagok:
    v_mov_b32 v70, 0
    s_mov_b64 exec, 1
    ds_write_b64 v70, v[68:69] offset:2048
    s_mov_b64 exec, -1
L1_notag2:
    s_movk_i32 s46, 0
    buffer_load_dwordx4 v[28:31], v65, s[72:75], s46 offen
    s_movk_i32 s46, 3072
    buffer_load_dwordx4 v[32:35], v65, s[72:75], s46 offen
    s_movk_i32 s46, 6144
    buffer_load_dwordx4 v[36:39], v65, s[72:75], s46 offen
    s_movk_i32 s46, 9216
    buffer_load_dwordx4 v[40:43], v65, s[72:75], s46 offen
    s_movk_i32 s46, 12288
    buffer_load_dwordx4 v[44:47], v65, s[72:75], s46 offen
    s_movk_i32 s46, 15360
    buffer_load_dwordx4 v[48:51], v65, s[72:75], s46 offen
    s_movk_i32 s46, 18432
    buffer_load_dwordx4 v[52:55], v65, s[72:75], s46 offen
    s_movk_i32 s46, 21504
    buffer_load_dwordx4 v[56:59], v65, s[72:75], s46 offen
    s_movk_i32 s46, 0
    buffer_load_dwordx4 v[72:75], v65, s[68:71], s46 offen
    s_movk_i32 s46, 3072
    buffer_load_dwordx4 v[76:79], v65, s[68:71], s46 offen
    s_movk_i32 s46, 6144
    buffer_load_dwordx4 v[80:83], v65, s[68:71], s46 offen
    s_movk_i32 s46, 9216
    buffer_load_dwordx4 v[84:87], v65, s[68:71], s46 offen
    s_movk_i32 s46, 12288
    buffer_load_dwordx4 v[88:91], v65, s[68:71], s46 offen
    s_movk_i32 s46, 15360
    buffer_load_dwordx4 v[92:95], v65, s[68:71], s46 offen
    s_mul_i32 s46, s31, 782
    s_add_u32 s46, s46, 96
    s_mov_b32 s47, 64
    v_add_u32 v60, 0, v64
    v_cmp_gt_u32 vcc, s47, v60
    v_add_u32 v60, s46, v60
    v_and_b32 v61, 1, v60
    v_lshrrev_b32 v60, 1, v60
    v_lshlrev_b32 v60, 9, v60
    v_lshl_add_u32 v60, v61, 7, v60
    v_cndmask_b32 v60, 2.0, v60, vcc
    buffer_load_dword v62, v60, s[4:7], 0 offen offset:0
    s_waitcnt lgkmcnt(0)
L1_copy:
    s_barrier
    v_mov_b32 v25, 119040
    ds_read_b32 v99, v25
    ds_read_b128 v[8:11], v1 offset:2176
    ds_read_b128 v[12:15], v1 offset:18560
    v_mov_b32 v25, 0
    ds_read_b96 v[96:98], v25 offset:2048
    v_add_u32 v25, 132352, v1
    ds_read_b128 v[16:19], v1 offset:34944
    ds_read_b128 v[20:23], v1 offset:51328
    ds_read_b128 v[100:103], v25
    v_lshrrev_b32 v25, 1, v0
    v_lshlrev_b32 v25, 2, v25
    v_add_u32 v25, 115968, v25
    ds_read2st64_b32 v[104:105], v25 offset0:0 offset1:8
    ds_read_b32 v106, v25 offset:1024
    v_add_u32 v2, 16384, v1
    v_add_u32 v25, 1024, v0
    s_waitcnt lgkmcnt(8)
    v_add_u32 v99, 7, v99
    v_and_b32 v99, -8, v99
    v_cmp_lt_u32 s[52:53], v0, v99
    v_cmp_lt_u32 s[54:55], v25, v99
    v_readfirstlane_b32 s88, v99
    v_add_u32 v3, 32768, v1
    v_add_u32 v24, 49152, v1
    s_mov_b64 exec, s[52:53]
    s_waitcnt lgkmcnt(7)
    buffer_store_dwordx4 v[8:11], v1, s[8:11], s51 offen sc1
    s_mov_b64 exec, s[54:55]
    s_cbranch_execz L1_nop1
    s_waitcnt lgkmcnt(6)
    buffer_store_dwordx4 v[12:15], v2, s[8:11], s51 offen sc1
L1_nop1:
    s_mov_b64 exec, -1
    s_movk_i32 s48, 128
    v_cmp_gt_u32 s[92:93], s48, v0
    s_waitcnt lgkmcnt(0)
    v_readfirstlane_b32 s86, v96
    v_readfirstlane_b32 s87, v97
    v_readfirstlane_b32 s42, v98
    v_lshl_or_b32 v104, v104, 12, v105
    v_or_b32 v104, v97, v104
    v_cndmask_b32 v100, v104, v100, s[26:27]
    v_cndmask_b32 v101, v96, v101, s[26:27]
    v_lshl_or_b32 v104, v96, 12, v106
    v_cndmask_b32 v103, v103, v104, s[26:27]
    s_lshl_b32 s3, s86, 12
    s_add_u32 s49, s51, 51200
    s_cmp_gt_u32 s88, 2048
    s_cselect_b32 s25, 0, 8
    s_cmp_eq_u32 s42, 0
    s_cbranch_scc1 L1_nokeyst
    s_add_u32 s42, s51, 16384
    v_subrev_u32 v25, 128, v0
    s_movk_i32 s43, 200
    v_cmp_gt_u32 vcc, s43, v25
    s_and_saveexec_b64 s[44:45], vcc
    s_cbranch_execz L1_nokeyst2
    buffer_store_dwordx4 v[20:23], v24, s[8:11], s42 offen sc1
L1_nokeyst2:
    s_mov_b64 exec, -1
L1_nokeyst:
    s_cmp_lt_u32 s21, 4
    s_cbranch_scc1 L2_gemm
    v_and_b32 v108, 63, v0
    v_mov_b32 v121, 1
    v_mov_b32 v112, s30
    v_lshrrev_b32 v120, 4, v108
    v_lshlrev_b32 v118, 4, v108
    v_and_b32 v119, 15, v108
    v_lshlrev_b32 v111, 4, v119
    s_sub_u32 s43, s21, 4
    s_mul_i32 s43, s43, 2368
    s_add_u32 s43, s43, 132352
    v_add_u32 v115, s43, v118
    v_lshlrev_b32 v114, 5, v120
    v_add_u32 v114, s43, v114
    v_lshlrev_b32 v116, 4, v120
    v_bfe_u32 v120, v108, 2, 2
    v_lshl_add_u32 v116, v120, 6, v116
    v_and_b32 v120, 1, v108
    v_lshl_add_u32 v116, v120, 3, v116
    v_bfe_u32 v120, v108, 1, 1
    v_mul_u32_u24 v120, 1056, v120
    v_add3_u32 v116, v116, v120, s43
    v_and_b32 v113, 32, v108
    v_and_b32 v120, 3, v108
    v_lshl_add_u32 v113, v120, 3, v113
    v_bfe_u32 v120, v108, 2, 3
    v_add_u32 v113, v113, v120
    v_lshlrev_b32 v113, 2, v113
    v_add_u32 v113, s43, v113
    v_add_u32 v117, 115968, v118
    s_sub_u32 s42, s21, 4
    s_mul_i32 s83, s42, 24
    v_and_b32 v123, 7, v108
    v_lshrrev_b32 v125, 3, v108
    s_mov_b32 s42, 70784
    v_mul_u32_u24 v124, s42, v125
    v_lshlrev_b32 v125, 5, v125
    v_add_u32 v125, s43, v125
    v_or_b32 v122, 0x0c0c0c00, v123
    s_mul_i32 s79, s83, 70784
    s_add_u32 s74, s79, 0
    s_add_u32 s80, s79, 67584
    s_add_u32 s75, s79, 566272
    s_add_u32 s81, s79, 633856
    s_add_u32 s76, s79, 1132544
    s_add_u32 s82, s79, 1200128
    s_mov_b32 s78, 0x100000
    s_mov_b32 s88, s20
    s_mov_b32 s89, 0
    s_movk_i32 s48, 25
    s_waitcnt vmcnt(0)
    s_barrier
    s_cmp_ge_u32 s21, s25
    s_cbranch_scc1 L_noearlyg
    buffer_store_dwordx4 v[100:103], v1, s[8:11], s49 offen sc1
L_noearlyg:
    buffer_store_dwordx4 v[16:19], v3, s[8:11], s51 offen sc1
    s_not_b64 exec, s[54:55]
    s_cbranch_execz L_stskipg0
    buffer_store_dwordx4 v[12:15], v2, s[8:11], s51 offen sc1
L_stskipg0:
    s_mov_b64 exec, s[92:93]
    s_cbranch_execz L_stskipg1
    buffer_store_dwordx4 v[20:23], v24, s[8:11], s51 offen sc1
L_stskipg1:
    s_not_b64 exec, s[52:53]
    s_cbranch_execz L_stskipg2
    buffer_store_dwordx4 v[8:11], v1, s[8:11], s51 offen sc1
L_stskipg2:
    s_mov_b64 exec, -1
    s_cmp_lt_u32 s21, 13
    s_cbranch_scc1 L2_noW
    v_add_u32 v65, 64768, v65
    ds_write_b128 v65, v[28:31] offset:16384
    ds_write_b128 v65, v[32:35] offset:19456
    ds_write_b128 v65, v[36:39] offset:22528
    ds_write_b128 v65, v[40:43] offset:25600
    ds_write_b128 v65, v[44:47] offset:28672
    ds_write_b128 v65, v[48:51] offset:31744
    ds_write_b128 v65, v[52:55] offset:34816
    ds_write_b128 v65, v[56:59] offset:37888
    ds_write_b128 v65, v[72:75] offset:0
    ds_write_b128 v65, v[76:79] offset:3072
    ds_write_b128 v65, v[80:83] offset:6144
    ds_write_b128 v65, v[84:87] offset:9216
    ds_write_b128 v65, v[88:91] offset:12288
    s_cmp_lg_u32 s21, 13
    s_cbranch_scc1 L2_noW
    ds_write_b128 v65, v[92:95] offset:15360
L2_noW:
    s_waitcnt vmcnt(0) lgkmcnt(0)
    s_barrier
    s_cmp_lt_u32 s21, s25
    s_cbranch_scc1 L_nolateg
    buffer_store_dwordx4 v[100:103], v1, s[8:11], s49 offen sc1
L_nolateg:
L2_g_round:
    v_and_b32 v123, 7, v108
    v_or_b32 v122, 0x0c0c0c00, v123
    v_lshrrev_b32 v64, 1, v108
    s_sub_u32 s42, 250, s83
    s_min_i32 s42, s42, 24
    v_cmp_gt_i32 s[46:47], s42, v64
    s_mov_b32 s42, 70784
    v_mul_u32_u24 v65, s42, v64
    v_and_b32 v66, 16, v118
    v_add_u32 v65, v65, v66
    v_cndmask_b32 v65, 2.0, v65, s[46:47]
    s_lshl_b32 s43, s88, 5
    s_add_u32 s43, s43, 51200
    s_add_u32 s43, s43, s79
    s_mov_b32 s44, 0
    v_lshl_add_u32 v120, v123, 4, v124
L2_poll:
    buffer_load_dwordx4 v[72:75], v65, s[8:11], s43 offen sc1
    s_add_u32 s44, s44, 1
    s_waitcnt vmcnt(0)
L2_poll_chk:
    v_xor_b32 v67, s87, v72
    v_xor_b32 v66, s86, v73
    v_lshrrev_b32 v67, 24, v67
    v_or_b32 v66, v66, v67
    v_xor_b32 v67, s3, v75
    v_lshrrev_b32 v67, 12, v67
    v_cndmask_b32 v66, v66, v67, s[26:27]
    v_cmp_ne_u32 vcc, 0, v66
    s_nop 1
    s_and_b64 vcc, vcc, s[46:47]
    s_cbranch_scc0 L2_poll_ok
    s_sleep 2
    s_cmp_lt_u32 s44, s78
    s_cbranch_scc1 L2_poll
    s_mov_b32 s78, 0
L2_poll_ok:
    s_cmp_lg_u32 s23, 1
    s_cbranch_scc1 L2_nofilter
    s_sub_u32 s42, s22, s83
    v_cmp_eq_u32 vcc, s42, v64
    s_nop 1
    v_cndmask_b32 v72, 0, v72, vcc
L2_nofilter:
    ds_write_b128 v115, v[72:75]
    v_add_u32 v65, 8, v123
    ds_read_b128 v[72:75], v125 offset:0
    ds_read_b128 v[76:79], v125 offset:16
    ds_read_b128 v[80:83], v125 offset:256
    ds_read_b128 v[84:87], v125 offset:272
    ds_read_b128 v[88:91], v125 offset:512
    ds_read_b128 v[92:95], v125 offset:528
    s_waitcnt lgkmcnt(0)
    v_bfe_u32 v54, v72, 12, 12
    v_and_b32 v60, 0xfff, v72
    v_cmp_lt_u32 s[50:51], v123, v54
    v_cmp_lt_u32 s[52:53], v65, v54
    v_perm_b32 v36, v75, v74, v122
    v_perm_b32 v37, v77, v76, v122
    v_lshl_add_u32 v60, v60, 4, v120
    s_mov_b64 exec, s[50:51]
    s_cbranch_execz L2_nop0
    ds_add_rtn_u32 v45, v36, v121 offset:0
    buffer_load_dwordx4 v[0:3], v60, s[8:11], s74 offen offset:0 sc1
    s_mov_b64 exec, s[52:53]
    s_cbranch_execz L2_nop0
    ds_add_rtn_u32 v46, v37, v121 offset:0
    buffer_load_dwordx4 v[4:7], v60, s[8:11], s74 offen offset:128 sc1
L2_nop0:
    s_mov_b64 exec, -1
    v_bfe_u32 v55, v80, 12, 12
    v_and_b32 v61, 0xfff, v80
    v_cmp_lt_u32 s[54:55], v123, v55
    v_cmp_lt_u32 s[56:57], v65, v55
    v_perm_b32 v39, v83, v82, v122
    v_perm_b32 v40, v85, v84, v122
    v_lshl_add_u32 v61, v61, 4, v120
    s_mov_b64 exec, s[54:55]
    s_cbranch_execz L2_nop1
    ds_add_rtn_u32 v48, v39, v121 offset:0
    buffer_load_dwordx4 v[12:15], v61, s[8:11], s75 offen offset:0 sc1
    s_mov_b64 exec, s[56:57]
    s_cbranch_execz L2_nop1
    ds_add_rtn_u32 v49, v40, v121 offset:0
    buffer_load_dwordx4 v[16:19], v61, s[8:11], s75 offen offset:128 sc1
L2_nop1:
    s_mov_b64 exec, -1
    v_bfe_u32 v56, v88, 12, 12
    v_and_b32 v62, 0xfff, v88
    v_cmp_lt_u32 s[58:59], v123, v56
    v_cmp_lt_u32 s[60:61], v65, v56
    v_perm_b32 v42, v91, v90, v122
    v_perm_b32 v43, v93, v92, v122
    v_lshl_add_u32 v62, v62, 4, v120
    s_mov_b64 exec, s[58:59]
    s_cbranch_execz L2_nop2
    ds_add_rtn_u32 v51, v42, v121 offset:0
    buffer_load_dwordx4 v[24:27], v62, s[8:11], s76 offen offset:0 sc1
    s_mov_b64 exec, s[60:61]
    s_cbranch_execz L2_nop2
    ds_add_rtn_u32 v52, v43, v121 offset:0
    buffer_load_dwordx4 v[28:31], v62, s[8:11], s76 offen offset:128 sc1
L2_nop2:
    s_mov_b64 exec, -1
    v_max3_u32 v119, v54, v55, v56
    v_cmp_lt_u32 vcc, 16, v119
    s_mov_b32 s25, 0
    s_nop 0
    s_cmp_eq_u64 vcc, 0
    s_cbranch_scc1 L2_noextraA
    s_mov_b32 s25, 1
    v_add_u32 v66, 16, v123
    v_min_u32 v67, 20, v54
    v_cmp_lt_u32 s[62:63], v66, v67
    v_perm_b32 v38, v78, v78, v122
    v_sub_u32 v57, v60, v124
    v_lshrrev_b32 v57, 4, v57
    v_add_u32 v57, v57, v124
    s_nop 1
    s_mov_b64 exec, s[62:63]
    ds_add_rtn_u32 v47, v38, v121 offset:0
    buffer_load_dwordx4 v[8:11], v60, s[8:11], s74 offen offset:256 sc1
    s_mov_b64 exec, -1
    v_min_u32 v67, 20, v55
    v_cmp_lt_u32 s[64:65], v66, v67
    v_perm_b32 v41, v86, v86, v122
    v_sub_u32 v58, v61, v124
    v_lshrrev_b32 v58, 4, v58
    v_add_u32 v58, v58, v124
    s_nop 1
    s_mov_b64 exec, s[64:65]
    ds_add_rtn_u32 v50, v41, v121 offset:0
    buffer_load_dwordx4 v[20:23], v61, s[8:11], s75 offen offset:256 sc1
    s_mov_b64 exec, -1
    v_min_u32 v67, 20, v56
    v_cmp_lt_u32 s[66:67], v66, v67
    v_perm_b32 v44, v94, v94, v122
    v_sub_u32 v59, v62, v124
    v_lshrrev_b32 v59, 4, v59
    v_add_u32 v59, v59, v124
    s_nop 1
    s_mov_b64 exec, s[66:67]
    ds_add_rtn_u32 v53, v44, v121 offset:0
    buffer_load_dwordx4 v[32:35], v62, s[8:11], s76 offen offset:256 sc1
    s_mov_b64 exec, -1
    v_add_u32 v64, 20, v123
    v_add_u32 v65, 20, v57
L_xaa0:
    v_cmp_lt_u32 vcc, v64, v54
    s_and_saveexec_b64 s[44:45], vcc
    s_nop 3
    s_cbranch_execz L_xaa0_done
    buffer_load_ubyte v66, v65, s[8:11], s80 offen sc1
    s_waitcnt vmcnt(0)
    ds_add_u32 v66, v121 offset:256
    s_mov_b64 exec, -1
    v_add_u32 v64, 8, v64
    v_add_u32 v65, 8, v65
    s_nop 1
    s_branch L_xaa0
L_xaa0_done:
    s_mov_b64 exec, -1
    v_add_u32 v64, 20, v123
    v_add_u32 v65, 20, v58
L_xaa1:
    v_cmp_lt_u32 vcc, v64, v55
    s_and_saveexec_b64 s[44:45], vcc
    s_nop 3
    s_cbranch_execz L_xaa1_done
    buffer_load_ubyte v66, v65, s[8:11], s81 offen sc1
    s_waitcnt vmcnt(0)
    ds_add_u32 v66, v121 offset:256
    s_mov_b64 exec, -1
    v_add_u32 v64, 8, v64
    v_add_u32 v65, 8, v65
    s_nop 1
    s_branch L_xaa1
L_xaa1_done:
    s_mov_b64 exec, -1
    v_add_u32 v64, 20, v123
    v_add_u32 v65, 20, v59
L_xaa2:
    v_cmp_lt_u32 vcc, v64, v56
    s_and_saveexec_b64 s[44:45], vcc
    s_nop 3
    s_cbranch_execz L_xaa2_done
    buffer_load_ubyte v66, v65, s[8:11], s82 offen sc1
    s_waitcnt vmcnt(0)
    ds_add_u32 v66, v121 offset:256
    s_mov_b64 exec, -1
    v_add_u32 v64, 8, v64
    v_add_u32 v65, 8, v65
    s_nop 1
    s_branch L_xaa2
L_xaa2_done:
    s_mov_b64 exec, -1
L2_noextraA:
    s_waitcnt lgkmcnt(0)
    s_barrier
    v_lshlrev_b32 v119, 2, v108
    ds_read_b32 v68, v119 offset:0
    ds_read_b32 v69, v119 offset:256
    s_waitcnt lgkmcnt(0)
    v_add_u32 v69, v68, v69
    v_mov_b32 v70, v69
    s_nop 1
    v_add_u32_dpp v70, v70, v70 row_shr:1 row_mask:0xf bank_mask:0xf
    s_nop 1
    v_add_u32_dpp v70, v70, v70 row_shr:2 row_mask:0xf bank_mask:0xf
    s_nop 1
    v_add_u32_dpp v70, v70, v70 row_shr:4 row_mask:0xf bank_mask:0xf
    s_nop 1
    v_add_u32_dpp v70, v70, v70 row_shr:8 row_mask:0xf bank_mask:0xf
    s_nop 1
    v_add_u32_dpp v70, v70, v70 row_bcast:15 row_mask:0xa bank_mask:0xf
    s_nop 1
    v_add_u32_dpp v70, v70, v70 row_bcast:31 row_mask:0xc bank_mask:0xf
    s_nop 0
    v_readlane_b32 s46, v70, 63
    v_sub_u32 v70, v70, v69
    s_cmp_eq_u32 s23, 1
    s_cselect_b32 s42, -1, 1888
    ds_bpermute_b32 v36, v36, v70
    ds_bpermute_b32 v37, v37, v70
    ds_bpermute_b32 v39, v39, v70
    ds_bpermute_b32 v40, v40, v70
    ds_bpermute_b32 v42, v42, v70
    ds_bpermute_b32 v43, v43, v70
    v_lshl_or_b32 v109, v69, 16, v70
    s_cmp_gt_u32 s46, s42
    s_cbranch_scc1 L2_g_overflow
    s_cmp_lg_u32 s21, 5
    s_cbranch_scc1 L2_noinfo
    s_mov_b64 exec, 33554431
    ds_write_b32 v119, v109 offset:1792
    s_mov_b64 exec, -1
L2_noinfo:
    s_cmp_lg_u32 s21, 4
    s_cbranch_scc1 L2_noguard
    s_lshl_b32 s46, s46, 4
    v_mov_b32 v72, 0
    v_mov_b32 v73, 0
    v_mov_b32 v74, 0
    v_mov_b32 v75, 0
    v_add_u32 v119, s46, v118
    ds_write_b128 v119, v[72:75] offset:2176
L2_noguard:
    s_waitcnt lgkmcnt(0)
    v_add_lshl_u32 v36, v36, v45, 4
    v_add_lshl_u32 v37, v37, v46, 4
    v_add_lshl_u32 v39, v39, v48, 4
    v_add_lshl_u32 v40, v40, v49, 4
    v_add_lshl_u32 v42, v42, v51, 4
    v_add_lshl_u32 v43, v43, v52, 4
    s_waitcnt vmcnt(0)
    s_mov_b64 exec, s[50:51]
    ds_write_b128 v36, v[0:3] offset:2176
    s_mov_b64 exec, s[52:53]
    ds_write_b128 v37, v[4:7] offset:2176
    s_mov_b64 exec, s[54:55]
    ds_write_b128 v39, v[12:15] offset:2176
    s_mov_b64 exec, s[56:57]
    ds_write_b128 v40, v[16:19] offset:2176
    s_mov_b64 exec, s[58:59]
    ds_write_b128 v42, v[24:27] offset:2176
    s_mov_b64 exec, s[60:61]
    ds_write_b128 v43, v[28:31] offset:2176
    s_mov_b64 exec, -1
    s_cmp_eq_u32 s25, 0
    s_cbranch_scc1 L2_noextraB
    ds_bpermute_b32 v38, v38, v70
    ds_bpermute_b32 v41, v41, v70
    ds_bpermute_b32 v44, v44, v70
    s_waitcnt lgkmcnt(0)
    v_add_lshl_u32 v38, v38, v47, 4
    s_mov_b64 exec, s[62:63]
    ds_write_b128 v38, v[8:11] offset:2176
    s_mov_b64 exec, -1
    v_add_lshl_u32 v41, v41, v50, 4
    s_mov_b64 exec, s[64:65]
    ds_write_b128 v41, v[20:23] offset:2176
    s_mov_b64 exec, -1
    v_add_lshl_u32 v44, v44, v53, 4
    s_mov_b64 exec, s[66:67]
    ds_write_b128 v44, v[32:35] offset:2176
    s_mov_b64 exec, -1
    v_add_u32 v70, v70, v68
    v_add_u32 v64, 20, v123
    v_add_u32 v65, 20, v57
    v_add_u32 v60, 320, v60
L_xba0:
    v_cmp_lt_u32 vcc, v64, v54
    s_and_saveexec_b64 s[44:45], vcc
    s_nop 3
    s_cbranch_execz L_xba0_done
    buffer_load_ubyte v66, v65, s[8:11], s80 offen sc1
    buffer_load_dwordx4 v[72:75], v60, s[8:11], s74 offen sc1
    s_waitcnt vmcnt(0)
    ds_add_rtn_u32 v67, v66, v121 offset:512
    s_mov_b64 exec, -1
    ds_bpermute_b32 v66, v66, v70
    s_waitcnt lgkmcnt(0)
    v_add_lshl_u32 v66, v66, v67, 4
    s_mov_b64 exec, vcc
    ds_write_b128 v66, v[72:75] offset:2176
    s_mov_b64 exec, -1
    v_add_u32 v64, 8, v64
    v_add_u32 v65, 8, v65
    v_add_u32 v60, 128, v60
    s_nop 1
    s_branch L_xba0
L_xba0_done:
    s_mov_b64 exec, -1
    v_add_u32 v64, 20, v123
    v_add_u32 v65, 20, v58
    v_add_u32 v61, 320, v61
L_xba1:
    v_cmp_lt_u32 vcc, v64, v55
    s_and_saveexec_b64 s[44:45], vcc
    s_nop 3
    s_cbranch_execz L_xba1_done
    buffer_load_ubyte v66, v65, s[8:11], s81 offen sc1
    buffer_load_dwordx4 v[72:75], v61, s[8:11], s75 offen sc1
    s_waitcnt vmcnt(0)
    ds_add_rtn_u32 v67, v66, v121 offset:512
    s_mov_b64 exec, -1
    ds_bpermute_b32 v66, v66, v70
    s_waitcnt lgkmcnt(0)
    v_add_lshl_u32 v66, v66, v67, 4
    s_mov_b64 exec, vcc
    ds_write_b128 v66, v[72:75] offset:2176
    s_mov_b64 exec, -1
    v_add_u32 v64, 8, v64
    v_add_u32 v65, 8, v65
    v_add_u32 v61, 128, v61
    s_nop 1
    s_branch L_xba1
L_xba1_done:
    s_mov_b64 exec, -1
    v_add_u32 v64, 20, v123
    v_add_u32 v65, 20, v59
    v_add_u32 v62, 320, v62
L_xba2:
    v_cmp_lt_u32 vcc, v64, v56
    s_and_saveexec_b64 s[44:45], vcc
    s_nop 3
    s_cbranch_execz L_xba2_done
    buffer_load_ubyte v66, v65, s[8:11], s82 offen sc1
    buffer_load_dwordx4 v[72:75], v62, s[8:11], s76 offen sc1
    s_waitcnt vmcnt(0)
    ds_add_rtn_u32 v67, v66, v121 offset:512
    s_mov_b64 exec, -1
    ds_bpermute_b32 v66, v66, v70
    s_waitcnt lgkmcnt(0)
    v_add_lshl_u32 v66, v66, v67, 4
    s_mov_b64 exec, vcc
    ds_write_b128 v66, v[72:75] offset:2176
    s_mov_b64 exec, -1
    v_add_u32 v64, 8, v64
    v_add_u32 v65, 8, v65
    v_add_u32 v62, 128, v62
    s_nop 1
    s_branch L_xba2
L_xba2_done:
    s_mov_b64 exec, -1
L2_noextraB:
    s_waitcnt lgkmcnt(0)
    s_barrier
    ds_read_b32 v119, v118 offset:872
    s_sub_u32 s42, s21, 16
    v_mov_b32 v110, s42
    s_waitcnt lgkmcnt(0)
    v_readfirstlane_b32 s42, v119
    s_nop 0
    s_cmp_gt_u32 s42, 1888
    s_cbranch_scc1 L2_g_overflow
    v_readfirstlane_b32 s42, v110
    s_nop 0
    s_add_u32 s42, s42, 12
    s_cmp_ge_u32 s42, 100
    s_cbranch_scc1 L2_g_done
    s_cmp_ge_u32 s42, 50
    s_cselect_b32 s34, 256, 0
    s_cselect_b32 s43, 50, 0
    s_cmp_ge_u32 s42, 66
    s_cselect_b32 s43, 18, s43
    s_cmp_ge_u32 s42, 68
    s_cselect_b32 s43, 52, s43
    s_sub_u32 s35, s42, s43
    s_cmp_lt_u32 s35, s48
    s_cbranch_scc1 L2_bw1
    v_mov_b32 v119, 0
    s_mov_b32 s45, 0
L_spL2_bw1:
    ds_read_b32 v120, v119 offset:868
    s_waitcnt lgkmcnt(0)
    v_readfirstlane_b32 s44, v120
    s_add_u32 s45, s45, 1
    s_cmp_ge_u32 s44, 4
    s_cbranch_scc1 L_spL2_bw1_ok
    s_sleep 1
    s_cmp_lt_u32 s45, 0x400000
    s_cbranch_scc1 L_spL2_bw1
L_spL2_bw1_ok:
    v_lshrrev_b32 v119, 2, v118
    ds_read_b32 v109, v119 offset:1792
    s_movk_i32 s48, 64
    s_waitcnt lgkmcnt(0)
L2_bw1:
    v_readlane_b32 s42, v109, s35
    s_nop 0
    s_lshr_b32 s33, s42, 16
    s_and_b32 s42, s42, 0xffff
    s_lshl_b32 s32, s42, 4
    v_add_u32 v119, s32, v118
    ds_read_b128 v[64:67], v119 offset:2176
    s_cmp_gt_u32 s33, 64
    s_cbranch_scc1 L2_nf4
    s_mov_b64 exec, 1
    ds_add_rtn_u32 v110, v118, v121 offset:768
    s_mov_b64 exec, -1
L2_nf4:
    v_cmp_gt_u32 vcc, s33, v108
    s_waitcnt lgkmcnt(0)
    v_lshrrev_b32 v75, 16, v67
    v_lshlrev_b32 v75, 9, v75
    v_cndmask_b32 v75, 2.0, v75, vcc
    ds_write_b32 v113, v75 offset:2080
    ds_read_b128 v[100:103], v114 offset:2080
    ds_read_b128 v[104:107], v114 offset:2096
    s_waitcnt lgkmcnt(0)
    v_add_u32 v100, v100, v111
    v_add_u32 v101, v101, v111
    v_add_u32 v102, v102, v111
    v_add_u32 v103, v103, v111
    v_add_u32 v104, v104, v111
    v_add_u32 v105, v105, v111
    v_add_u32 v106, v106, v111
    v_add_u32 v107, v107, v111
    buffer_load_dwordx4 v[32:35], v100, s[4:7], s34 offen
    buffer_load_dwordx4 v[36:39], v101, s[4:7], s34 offen
    buffer_load_dwordx4 v[40:43], v102, s[4:7], s34 offen
    buffer_load_dwordx4 v[44:47], v103, s[4:7], s34 offen
    buffer_load_dwordx4 v[48:51], v104, s[4:7], s34 offen
    buffer_load_dwordx4 v[52:55], v105, s[4:7], s34 offen
    buffer_load_dwordx4 v[56:59], v106, s[4:7], s34 offen
    buffer_load_dwordx4 v[60:63], v107, s[4:7], s34 offen
    v_cndmask_b32 v64, 0, v64, vcc
    v_cndmask_b32 v65, 0, v65, vcc
    v_lshlrev_b32 v72, 16, v66
    v_and_b32 v73, v112, v66
    v_lshlrev_b32 v74, 16, v67
    v_lshlrev_b32 v68, 16, v64
    v_and_b32 v69, v112, v64
    v_lshlrev_b32 v70, 16, v65
    v_and_b32 v71, v112, v65
    v_mul_f32 v76, v68, v72
    v_mul_f32 v77, v69, v72
    v_mul_f32 v78, v70, v72
    v_mul_f32 v79, v71, v72
    v_mul_f32 v80, v68, v73
    v_mul_f32 v81, v69, v73
    v_mul_f32 v82, v70, v73
    v_mul_f32 v83, v71, v73
    v_mul_f32 v84, v68, v74
    v_mul_f32 v85, v69, v74
    v_mul_f32 v86, v70, v74
    v_mul_f32 v87, v71, v74
    v_cvt_pk_bf16_f32 v66, v76, v77
    v_cvt_pk_bf16_f32 v67, v78, v79
    v_cvt_pk_bf16_f32 v88, v80, v81
    v_cvt_pk_bf16_f32 v89, v82, v83
    v_cvt_pk_bf16_f32 v90, v84, v85
    v_cvt_pk_bf16_f32 v91, v86, v87
    ds_write_b128 v115, v[64:67]
    ds_write_b128 v115, v[88:91] offset:1056
L2_A1:
    ds_read_b64_tr_b16 v[96:97], v116 offset:0
    ds_read_b64_tr_b16 v[98:99], v116 offset:256
    s_cmp_gt_u32 s33, 32
    s_cbranch_scc1 L2_AB1
    s_mov_b32 s40, 1
    s_mov_b32 s41, s33
    s_branch L2_XN
L2_AB1:
    ds_read_b128 v[100:103], v114 offset:2208
    ds_read_b128 v[104:107], v114 offset:2224
    s_sub_u32 s36, s33, 32
    s_waitcnt lgkmcnt(0)
    v_add_u32 v100, v100, v111
    v_add_u32 v101, v101, v111
    v_add_u32 v102, v102, v111
    v_add_u32 v103, v103, v111
    v_add_u32 v104, v104, v111
    v_add_u32 v105, v105, v111
    v_add_u32 v106, v106, v111
    v_add_u32 v107, v107, v111
    s_waitcnt vmcnt(0)
    s_cmp_le_u32 s36, 28
    s_cbranch_scc1 L2_pp5
    v_perm_b32 v64, v36, v32, s28
    v_perm_b32 v68, v36, v32, s29
    v_perm_b32 v72, v37, v33, s28
    v_perm_b32 v76, v37, v33, s29
    v_perm_b32 v80, v38, v34, s28
    v_perm_b32 v84, v38, v34, s29
    v_perm_b32 v88, v39, v35, s28
    v_perm_b32 v92, v39, v35, s29
    buffer_load_dwordx4 v[32:35], v100, s[4:7], s34 offen
    buffer_load_dwordx4 v[36:39], v101, s[4:7], s34 offen
    v_perm_b32 v65, v44, v40, s28
    v_perm_b32 v69, v44, v40, s29
    v_perm_b32 v73, v45, v41, s28
    v_perm_b32 v77, v45, v41, s29
    v_perm_b32 v81, v46, v42, s28
    v_perm_b32 v85, v46, v42, s29
    v_perm_b32 v89, v47, v43, s28
    v_perm_b32 v93, v47, v43, s29
    buffer_load_dwordx4 v[40:43], v102, s[4:7], s34 offen
    buffer_load_dwordx4 v[44:47], v103, s[4:7], s34 offen
    v_perm_b32 v66, v52, v48, s28
    v_perm_b32 v70, v52, v48, s29
    v_perm_b32 v74, v53, v49, s28
    v_perm_b32 v78, v53, v49, s29
    v_perm_b32 v82, v54, v50, s28
    v_perm_b32 v86, v54, v50, s29
    v_perm_b32 v90, v55, v51, s28
    v_perm_b32 v94, v55, v51, s29
    buffer_load_dwordx4 v[48:51], v104, s[4:7], s34 offen
    buffer_load_dwordx4 v[52:55], v105, s[4:7], s34 offen
    v_perm_b32 v67, v60, v56, s28
    v_perm_b32 v71, v60, v56, s29
    v_perm_b32 v75, v61, v57, s28
    v_perm_b32 v79, v61, v57, s29
    v_perm_b32 v83, v62, v58, s28
    v_perm_b32 v87, v62, v58, s29
    v_perm_b32 v91, v63, v59, s28
    v_perm_b32 v95, v63, v59, s29
    buffer_load_dwordx4 v[56:59], v106, s[4:7], s34 offen
    buffer_load_dwordx4 v[60:63], v107, s[4:7], s34 offen
    s_branch L2_pd6
L2_pp5:
    v_perm_b32 v64, v36, v32, s28
    v_perm_b32 v68, v36, v32, s29
    v_perm_b32 v72, v37, v33, s28
    v_perm_b32 v76, v37, v33, s29
    v_perm_b32 v80, v38, v34, s28
    v_perm_b32 v84, v38, v34, s29
    v_perm_b32 v88, v39, v35, s28
    v_perm_b32 v92, v39, v35, s29
    v_perm_b32 v65, v44, v40, s28
    v_perm_b32 v69, v44, v40, s29
    v_perm_b32 v73, v45, v41, s28
    v_perm_b32 v77, v45, v41, s29
    v_perm_b32 v81, v46, v42, s28
    v_perm_b32 v85, v46, v42, s29
    v_perm_b32 v89, v47, v43, s28
    v_perm_b32 v93, v47, v43, s29
    v_perm_b32 v66, v52, v48, s28
    v_perm_b32 v70, v52, v48, s29
    v_perm_b32 v74, v53, v49, s28
    v_perm_b32 v78, v53, v49, s29
    v_perm_b32 v82, v54, v50, s28
    v_perm_b32 v86, v54, v50, s29
    v_perm_b32 v90, v55, v51, s28
    v_perm_b32 v94, v55, v51, s29
    v_perm_b32 v67, v60, v56, s28
    v_perm_b32 v71, v60, v56, s29
    v_perm_b32 v75, v61, v57, s28
    v_perm_b32 v79, v61, v57, s29
    v_perm_b32 v83, v62, v58, s28
    v_perm_b32 v87, v62, v58, s29
    v_perm_b32 v91, v63, v59, s28
    v_perm_b32 v95, v63, v59, s29
    s_cmp_le_u32 s36, 0
    s_cbranch_scc1 L2_pd6
    buffer_load_dwordx4 v[32:35], v100, s[4:7], s34 offen
    s_cmp_le_u32 s36, 4
    s_cbranch_scc1 L2_pd6
    buffer_load_dwordx4 v[36:39], v101, s[4:7], s34 offen
    s_cmp_le_u32 s36, 8
    s_cbranch_scc1 L2_pd6
    buffer_load_dwordx4 v[40:43], v102, s[4:7], s34 offen
    s_cmp_le_u32 s36, 12
    s_cbranch_scc1 L2_pd6
    buffer_load_dwordx4 v[44:47], v103, s[4:7], s34 offen
    s_cmp_le_u32 s36, 16
    s_cbranch_scc1 L2_pd6
    buffer_load_dwordx4 v[48:51], v104, s[4:7], s34 offen
    s_cmp_le_u32 s36, 20
    s_cbranch_scc1 L2_pd6
    buffer_load_dwordx4 v[52:55], v105, s[4:7], s34 offen
    s_cmp_le_u32 s36, 24
    s_cbranch_scc1 L2_pd6
    buffer_load_dwordx4 v[56:59], v106, s[4:7], s34 offen
L2_pd6:
    v_mfma_f32_16x16x32_bf16 v[0:3], v[96:99], v[64:67], 0
    v_mfma_f32_16x16x32_bf16 v[4:7], v[96:99], v[68:71], 0
    v_mfma_f32_16x16x32_bf16 v[8:11], v[96:99], v[72:75], 0
    v_mfma_f32_16x16x32_bf16 v[12:15], v[96:99], v[76:79], 0
    v_mfma_f32_16x16x32_bf16 v[16:19], v[96:99], v[80:83], 0
    v_mfma_f32_16x16x32_bf16 v[20:23], v[96:99], v[84:87], 0
    v_mfma_f32_16x16x32_bf16 v[24:27], v[96:99], v[88:91], 0
    v_mfma_f32_16x16x32_bf16 v[28:31], v[96:99], v[92:95], 0
    s_branch L2_B
L2_A0:
    ds_read_b64_tr_b16 v[96:97], v116 offset:0
    ds_read_b64_tr_b16 v[98:99], v116 offset:256
    s_cmp_gt_u32 s33, 32
    s_cbranch_scc1 L2_AB0
    s_mov_b32 s40, 0
    s_mov_b32 s41, s33
    s_branch L2_XN
L2_AB0:
    ds_read_b128 v[100:103], v114 offset:2208
    ds_read_b128 v[104:107], v114 offset:2224
    s_sub_u32 s36, s33, 32
    s_waitcnt lgkmcnt(0)
    v_add_u32 v100, v100, v111
    v_add_u32 v101, v101, v111
    v_add_u32 v102, v102, v111
    v_add_u32 v103, v103, v111
    v_add_u32 v104, v104, v111
    v_add_u32 v105, v105, v111
    v_add_u32 v106, v106, v111
    v_add_u32 v107, v107, v111
    s_waitcnt vmcnt(0)
    s_cmp_le_u32 s36, 28
    s_cbranch_scc1 L2_pp7
    v_perm_b32 v64, v36, v32, s28
    v_perm_b32 v68, v36, v32, s29
    v_perm_b32 v72, v37, v33, s28
    v_perm_b32 v76, v37, v33, s29
    v_perm_b32 v80, v38, v34, s28
    v_perm_b32 v84, v38, v34, s29
    v_perm_b32 v88, v39, v35, s28
    v_perm_b32 v92, v39, v35, s29
    buffer_load_dwordx4 v[32:35], v100, s[4:7], s34 offen
    buffer_load_dwordx4 v[36:39], v101, s[4:7], s34 offen
    v_perm_b32 v65, v44, v40, s28
    v_perm_b32 v69, v44, v40, s29
    v_perm_b32 v73, v45, v41, s28
    v_perm_b32 v77, v45, v41, s29
    v_perm_b32 v81, v46, v42, s28
    v_perm_b32 v85, v46, v42, s29
    v_perm_b32 v89, v47, v43, s28
    v_perm_b32 v93, v47, v43, s29
    buffer_load_dwordx4 v[40:43], v102, s[4:7], s34 offen
    buffer_load_dwordx4 v[44:47], v103, s[4:7], s34 offen
    v_perm_b32 v66, v52, v48, s28
    v_perm_b32 v70, v52, v48, s29
    v_perm_b32 v74, v53, v49, s28
    v_perm_b32 v78, v53, v49, s29
    v_perm_b32 v82, v54, v50, s28
    v_perm_b32 v86, v54, v50, s29
    v_perm_b32 v90, v55, v51, s28
    v_perm_b32 v94, v55, v51, s29
    buffer_load_dwordx4 v[48:51], v104, s[4:7], s34 offen
    buffer_load_dwordx4 v[52:55], v105, s[4:7], s34 offen
    v_perm_b32 v67, v60, v56, s28
    v_perm_b32 v71, v60, v56, s29
    v_perm_b32 v75, v61, v57, s28
    v_perm_b32 v79, v61, v57, s29
    v_perm_b32 v83, v62, v58, s28
    v_perm_b32 v87, v62, v58, s29
    v_perm_b32 v91, v63, v59, s28
    v_perm_b32 v95, v63, v59, s29
    buffer_load_dwordx4 v[56:59], v106, s[4:7], s34 offen
    buffer_load_dwordx4 v[60:63], v107, s[4:7], s34 offen
    s_branch L2_pd8
L2_pp7:
    v_perm_b32 v64, v36, v32, s28
    v_perm_b32 v68, v36, v32, s29
    v_perm_b32 v72, v37, v33, s28
    v_perm_b32 v76, v37, v33, s29
    v_perm_b32 v80, v38, v34, s28
    v_perm_b32 v84, v38, v34, s29
    v_perm_b32 v88, v39, v35, s28
    v_perm_b32 v92, v39, v35, s29
    v_perm_b32 v65, v44, v40, s28
    v_perm_b32 v69, v44, v40, s29
    v_perm_b32 v73, v45, v41, s28
    v_perm_b32 v77, v45, v41, s29
    v_perm_b32 v81, v46, v42, s28
    v_perm_b32 v85, v46, v42, s29
    v_perm_b32 v89, v47, v43, s28
    v_perm_b32 v93, v47, v43, s29
    v_perm_b32 v66, v52, v48, s28
    v_perm_b32 v70, v52, v48, s29
    v_perm_b32 v74, v53, v49, s28
    v_perm_b32 v78, v53, v49, s29
    v_perm_b32 v82, v54, v50, s28
    v_perm_b32 v86, v54, v50, s29
    v_perm_b32 v90, v55, v51, s28
    v_perm_b32 v94, v55, v51, s29
    v_perm_b32 v67, v60, v56, s28
    v_perm_b32 v71, v60, v56, s29
    v_perm_b32 v75, v61, v57, s28
    v_perm_b32 v79, v61, v57, s29
    v_perm_b32 v83, v62, v58, s28
    v_perm_b32 v87, v62, v58, s29
    v_perm_b32 v91, v63, v59, s28
    v_perm_b32 v95, v63, v59, s29
    s_cmp_le_u32 s36, 0
    s_cbranch_scc1 L2_pd8
    buffer_load_dwordx4 v[32:35], v100, s[4:7], s34 offen
    s_cmp_le_u32 s36, 4
    s_cbranch_scc1 L2_pd8
    buffer_load_dwordx4 v[36:39], v101, s[4:7], s34 offen
    s_cmp_le_u32 s36, 8
    s_cbranch_scc1 L2_pd8
    buffer_load_dwordx4 v[40:43], v102, s[4:7], s34 offen
    s_cmp_le_u32 s36, 12
    s_cbranch_scc1 L2_pd8
    buffer_load_dwordx4 v[44:47], v103, s[4:7], s34 offen
    s_cmp_le_u32 s36, 16
    s_cbranch_scc1 L2_pd8
    buffer_load_dwordx4 v[48:51], v104, s[4:7], s34 offen
    s_cmp_le_u32 s36, 20
    s_cbranch_scc1 L2_pd8
    buffer_load_dwordx4 v[52:55], v105, s[4:7], s34 offen
    s_cmp_le_u32 s36, 24
    s_cbranch_scc1 L2_pd8
    buffer_load_dwordx4 v[56:59], v106, s[4:7], s34 offen
L2_pd8:
    v_mfma_f32_16x16x32_bf16 v[0:3], v[96:99], v[64:67], v[0:3]
    v_mfma_f32_16x16x32_bf16 v[4:7], v[96:99], v[68:71], v[4:7]
    v_mfma_f32_16x16x32_bf16 v[8:11], v[96:99], v[72:75], v[8:11]
    v_mfma_f32_16x16x32_bf16 v[12:15], v[96:99], v[76:79], v[12:15]
    v_mfma_f32_16x16x32_bf16 v[16:19], v[96:99], v[80:83], v[16:19]
    v_mfma_f32_16x16x32_bf16 v[20:23], v[96:99], v[84:87], v[20:23]
    v_mfma_f32_16x16x32_bf16 v[24:27], v[96:99], v[88:91], v[24:27]
    v_mfma_f32_16x16x32_bf16 v[28:31], v[96:99], v[92:95], v[28:31]
L2_B:
    ds_read_b64_tr_b16 v[96:97], v116 offset:512
    ds_read_b64_tr_b16 v[98:99], v116 offset:768
    s_cmp_gt_u32 s33, 64
    s_cbranch_scc0 L2_BN
    s_sub_u32 s33, s33, 64
    s_add_u32 s32, s32, 1024
    s_mov_b32 s36, s33
    v_add_u32 v119, s32, v118
    ds_read_b128 v[64:67], v119 offset:2176
    s_cmp_gt_u32 s33, 64
    s_cbranch_scc1 L2_nf9
    s_mov_b64 exec, 1
    ds_add_rtn_u32 v110, v118, v121 offset:768
    s_mov_b64 exec, -1
L2_nf9:
    v_cmp_gt_u32 vcc, s33, v108
    s_waitcnt lgkmcnt(0)
    v_lshrrev_b32 v75, 16, v67
    v_lshlrev_b32 v75, 9, v75
    v_cndmask_b32 v75, 2.0, v75, vcc
    ds_write_b32 v113, v75 offset:2080
    ds_read_b128 v[100:103], v114 offset:2080
    ds_read_b128 v[104:107], v114 offset:2096
    v_cndmask_b32 v64, 0, v64, vcc
    v_cndmask_b32 v65, 0, v65, vcc
    v_lshlrev_b32 v72, 16, v66
    v_and_b32 v73, v112, v66
    v_lshlrev_b32 v74, 16, v67
    v_lshlrev_b32 v68, 16, v64
    v_and_b32 v69, v112, v64
    v_lshlrev_b32 v70, 16, v65
    v_and_b32 v71, v112, v65
    v_mul_f32 v76, v68, v72
    v_mul_f32 v77, v69, v72
    v_mul_f32 v78, v70, v72
    v_mul_f32 v79, v71, v72
    v_mul_f32 v80, v68, v73
    v_mul_f32 v81, v69, v73
    v_mul_f32 v82, v70, v73
    v_mul_f32 v83, v71, v73
    v_mul_f32 v84, v68, v74
    v_mul_f32 v85, v69, v74
    v_mul_f32 v86, v70, v74
    v_mul_f32 v87, v71, v74
    v_cvt_pk_bf16_f32 v66, v76, v77
    v_cvt_pk_bf16_f32 v67, v78, v79
    v_cvt_pk_bf16_f32 v88, v80, v81
    v_cvt_pk_bf16_f32 v89, v82, v83
    v_cvt_pk_bf16_f32 v90, v84, v85
    v_cvt_pk_bf16_f32 v91, v86, v87
    ds_write_b128 v115, v[64:67]
    ds_write_b128 v115, v[88:91] offset:1056
    s_waitcnt lgkmcnt(2)
    v_add_u32 v100, v100, v111
    v_add_u32 v101, v101, v111
    v_add_u32 v102, v102, v111
    v_add_u32 v103, v103, v111
    v_add_u32 v104, v104, v111
    v_add_u32 v105, v105, v111
    v_add_u32 v106, v106, v111
    v_add_u32 v107, v107, v111
    s_waitcnt vmcnt(0)
    s_cmp_le_u32 s36, 28
    s_cbranch_scc1 L2_pp10
    v_perm_b32 v64, v36, v32, s28
    v_perm_b32 v68, v36, v32, s29
    v_perm_b32 v72, v37, v33, s28
    v_perm_b32 v76, v37, v33, s29
    v_perm_b32 v80, v38, v34, s28
    v_perm_b32 v84, v38, v34, s29
    v_perm_b32 v88, v39, v35, s28
    v_perm_b32 v92, v39, v35, s29
    buffer_load_dwordx4 v[32:35], v100, s[4:7], s34 offen
    buffer_load_dwordx4 v[36:39], v101, s[4:7], s34 offen
    v_perm_b32 v65, v44, v40, s28
    v_perm_b32 v69, v44, v40, s29
    v_perm_b32 v73, v45, v41, s28
    v_perm_b32 v77, v45, v41, s29
    v_perm_b32 v81, v46, v42, s28
    v_perm_b32 v85, v46, v42, s29
    v_perm_b32 v89, v47, v43, s28
    v_perm_b32 v93, v47, v43, s29
    buffer_load_dwordx4 v[40:43], v102, s[4:7], s34 offen
    buffer_load_dwordx4 v[44:47], v103, s[4:7], s34 offen
    v_perm_b32 v66, v52, v48, s28
    v_perm_b32 v70, v52, v48, s29
    v_perm_b32 v74, v53, v49, s28
    v_perm_b32 v78, v53, v49, s29
    v_perm_b32 v82, v54, v50, s28
    v_perm_b32 v86, v54, v50, s29
    v_perm_b32 v90, v55, v51, s28
    v_perm_b32 v94, v55, v51, s29
    buffer_load_dwordx4 v[48:51], v104, s[4:7], s34 offen
    buffer_load_dwordx4 v[52:55], v105, s[4:7], s34 offen
    v_perm_b32 v67, v60, v56, s28
    v_perm_b32 v71, v60, v56, s29
    v_perm_b32 v75, v61, v57, s28
    v_perm_b32 v79, v61, v57, s29
    v_perm_b32 v83, v62, v58, s28
    v_perm_b32 v87, v62, v58, s29
    v_perm_b32 v91, v63, v59, s28
    v_perm_b32 v95, v63, v59, s29
    buffer_load_dwordx4 v[56:59], v106, s[4:7], s34 offen
    buffer_load_dwordx4 v[60:63], v107, s[4:7], s34 offen
    s_branch L2_pd11
L2_pp10:
    v_perm_b32 v64, v36, v32, s28
    v_perm_b32 v68, v36, v32, s29
    v_perm_b32 v72, v37, v33, s28
    v_perm_b32 v76, v37, v33, s29
    v_perm_b32 v80, v38, v34, s28
    v_perm_b32 v84, v38, v34, s29
    v_perm_b32 v88, v39, v35, s28
    v_perm_b32 v92, v39, v35, s29
    v_perm_b32 v65, v44, v40, s28
    v_perm_b32 v69, v44, v40, s29
    v_perm_b32 v73, v45, v41, s28
    v_perm_b32 v77, v45, v41, s29
    v_perm_b32 v81, v46, v42, s28
    v_perm_b32 v85, v46, v42, s29
    v_perm_b32 v89, v47, v43, s28
    v_perm_b32 v93, v47, v43, s29
    v_perm_b32 v66, v52, v48, s28
    v_perm_b32 v70, v52, v48, s29
    v_perm_b32 v74, v53, v49, s28
    v_perm_b32 v78, v53, v49, s29
    v_perm_b32 v82, v54, v50, s28
    v_perm_b32 v86, v54, v50, s29
    v_perm_b32 v90, v55, v51, s28
    v_perm_b32 v94, v55, v51, s29
    v_perm_b32 v67, v60, v56, s28
    v_perm_b32 v71, v60, v56, s29
    v_perm_b32 v75, v61, v57, s28
    v_perm_b32 v79, v61, v57, s29
    v_perm_b32 v83, v62, v58, s28
    v_perm_b32 v87, v62, v58, s29
    v_perm_b32 v91, v63, v59, s28
    v_perm_b32 v95, v63, v59, s29
    s_cmp_le_u32 s36, 0
    s_cbranch_scc1 L2_pd11
    buffer_load_dwordx4 v[32:35], v100, s[4:7], s34 offen
    s_cmp_le_u32 s36, 4
    s_cbranch_scc1 L2_pd11
    buffer_load_dwordx4 v[36:39], v101, s[4:7], s34 offen
    s_cmp_le_u32 s36, 8
    s_cbranch_scc1 L2_pd11
    buffer_load_dwordx4 v[40:43], v102, s[4:7], s34 offen
    s_cmp_le_u32 s36, 12
    s_cbranch_scc1 L2_pd11
    buffer_load_dwordx4 v[44:47], v103, s[4:7], s34 offen
    s_cmp_le_u32 s36, 16
    s_cbranch_scc1 L2_pd11
    buffer_load_dwordx4 v[48:51], v104, s[4:7], s34 offen
    s_cmp_le_u32 s36, 20
    s_cbranch_scc1 L2_pd11
    buffer_load_dwordx4 v[52:55], v105, s[4:7], s34 offen
    s_cmp_le_u32 s36, 24
    s_cbranch_scc1 L2_pd11
    buffer_load_dwordx4 v[56:59], v106, s[4:7], s34 offen
L2_pd11:
    s_waitcnt lgkmcnt(0)
    v_mfma_f32_16x16x32_bf16 v[0:3], v[96:99], v[64:67], v[0:3]
    v_mfma_f32_16x16x32_bf16 v[4:7], v[96:99], v[68:71], v[4:7]
    v_mfma_f32_16x16x32_bf16 v[8:11], v[96:99], v[72:75], v[8:11]
    v_mfma_f32_16x16x32_bf16 v[12:15], v[96:99], v[76:79], v[12:15]
    v_mfma_f32_16x16x32_bf16 v[16:19], v[96:99], v[80:83], v[16:19]
    v_mfma_f32_16x16x32_bf16 v[20:23], v[96:99], v[84:87], v[20:23]
    v_mfma_f32_16x16x32_bf16 v[24:27], v[96:99], v[88:91], v[24:27]
    v_mfma_f32_16x16x32_bf16 v[28:31], v[96:99], v[92:95], v[28:31]
    s_branch L2_A0
L2_BN:
    s_mov_b32 s40, 0
    s_sub_u32 s41, s33, 32
L2_XN:
    s_mov_b32 s38, s35
    s_mov_b32 s39, s34
    s_mov_b32 s37, 1
    v_readfirstlane_b32 s42, v110
    s_nop 0
    s_add_u32 s42, s42, 12
    s_cmp_ge_u32 s42, 100
    s_cbranch_scc1 L2_XN_none
    s_cmp_ge_u32 s42, 50
    s_cselect_b32 s34, 256, 0
    s_cselect_b32 s43, 50, 0
    s_cmp_ge_u32 s42, 66
    s_cselect_b32 s43, 18, s43
    s_cmp_ge_u32 s42, 68
    s_cselect_b32 s43, 52, s43
    s_sub_u32 s35, s42, s43
    s_cmp_lt_u32 s35, s48
    s_cbranch_scc1 L2_bw12
    v_mov_b32 v119, 0
    s_mov_b32 s45, 0
L_spL2_bw12:
    ds_read_b32 v120, v119 offset:868
    s_waitcnt lgkmcnt(0)
    v_readfirstlane_b32 s44, v120
    s_add_u32 s45, s45, 1
    s_cmp_ge_u32 s44, 4
    s_cbranch_scc1 L_spL2_bw12_ok
    s_sleep 1
    s_cmp_lt_u32 s45, 0x400000
    s_cbranch_scc1 L_spL2_bw12
L_spL2_bw12_ok:
    v_lshrrev_b32 v119, 2, v118
    ds_read_b32 v109, v119 offset:1792
    s_movk_i32 s48, 64
    s_waitcnt lgkmcnt(0)
L2_bw12:
    v_readlane_b32 s42, v109, s35
    s_nop 0
    s_lshr_b32 s33, s42, 16
    s_and_b32 s42, s42, 0xffff
    s_lshl_b32 s32, s42, 4
    s_mov_b32 s36, s33
    v_add_u32 v119, s32, v118
    ds_read_b128 v[64:67], v119 offset:2176
    s_cmp_gt_u32 s33, 64
    s_cbranch_scc1 L2_nf15
    s_mov_b64 exec, 1
    ds_add_rtn_u32 v110, v118, v121 offset:768
    s_mov_b64 exec, -1
L2_nf15:
    v_cmp_gt_u32 vcc, s33, v108
    s_waitcnt lgkmcnt(0)
    v_lshrrev_b32 v75, 16, v67
    v_lshlrev_b32 v75, 9, v75
    v_cndmask_b32 v75, 2.0, v75, vcc
    ds_write_b32 v113, v75 offset:2080
    ds_read_b128 v[100:103], v114 offset:2080
    ds_read_b128 v[104:107], v114 offset:2096
    v_cndmask_b32 v64, 0, v64, vcc
    v_cndmask_b32 v65, 0, v65, vcc
    v_lshlrev_b32 v72, 16, v66
    v_and_b32 v73, v112, v66
    v_lshlrev_b32 v74, 16, v67
    v_lshlrev_b32 v68, 16, v64
    v_and_b32 v69, v112, v64
    v_lshlrev_b32 v70, 16, v65
    v_and_b32 v71, v112, v65
    v_mul_f32 v76, v68, v72
    v_mul_f32 v77, v69, v72
    v_mul_f32 v78, v70, v72
    v_mul_f32 v79, v71, v72
    v_mul_f32 v80, v68, v73
    v_mul_f32 v81, v69, v73
    v_mul_f32 v82, v70, v73
    v_mul_f32 v83, v71, v73
    v_mul_f32 v84, v68, v74
    v_mul_f32 v85, v69, v74
    v_mul_f32 v86, v70, v74
    v_mul_f32 v87, v71, v74
    v_cvt_pk_bf16_f32 v66, v76, v77
    v_cvt_pk_bf16_f32 v67, v78, v79
    v_cvt_pk_bf16_f32 v88, v80, v81
    v_cvt_pk_bf16_f32 v89, v82, v83
    v_cvt_pk_bf16_f32 v90, v84, v85
    v_cvt_pk_bf16_f32 v91, v86, v87
    ds_write_b128 v115, v[64:67]
    ds_write_b128 v115, v[88:91] offset:1056
    s_waitcnt lgkmcnt(2)
    v_add_u32 v100, v100, v111
    v_add_u32 v101, v101, v111
    v_add_u32 v102, v102, v111
    v_add_u32 v103, v103, v111
    v_add_u32 v104, v104, v111
    v_add_u32 v105, v105, v111
    v_add_u32 v106, v106, v111
    v_add_u32 v107, v107, v111
    s_branch L2_XN_go
L2_XN_none:
    s_mov_b32 s37, 0
    s_mov_b32 s36, 0
L2_XN_go:
    s_cmp_le_u32 s41, 16
    s_cbranch_scc1 L2_XN_k16
    s_waitcnt vmcnt(0)
    s_cmp_le_u32 s36, 28
    s_cbranch_scc1 L2_pp16
    v_perm_b32 v64, v36, v32, s28
    v_perm_b32 v68, v36, v32, s29
    v_perm_b32 v72, v37, v33, s28
    v_perm_b32 v76, v37, v33, s29
    v_perm_b32 v80, v38, v34, s28
    v_perm_b32 v84, v38, v34, s29
    v_perm_b32 v88, v39, v35, s28
    v_perm_b32 v92, v39, v35, s29
    buffer_load_dwordx4 v[32:35], v100, s[4:7], s34 offen
    buffer_load_dwordx4 v[36:39], v101, s[4:7], s34 offen
    v_perm_b32 v65, v44, v40, s28
    v_perm_b32 v69, v44, v40, s29
    v_perm_b32 v73, v45, v41, s28
    v_perm_b32 v77, v45, v41, s29
    v_perm_b32 v81, v46, v42, s28
    v_perm_b32 v85, v46, v42, s29
    v_perm_b32 v89, v47, v43, s28
    v_perm_b32 v93, v47, v43, s29
    buffer_load_dwordx4 v[40:43], v102, s[4:7], s34 offen
    buffer_load_dwordx4 v[44:47], v103, s[4:7], s34 offen
    v_perm_b32 v66, v52, v48, s28
    v_perm_b32 v70, v52, v48, s29
    v_perm_b32 v74, v53, v49, s28
    v_perm_b32 v78, v53, v49, s29
    v_perm_b32 v82, v54, v50, s28
    v_perm_b32 v86, v54, v50, s29
    v_perm_b32 v90, v55, v51, s28
    v_perm_b32 v94, v55, v51, s29
    buffer_load_dwordx4 v[48:51], v104, s[4:7], s34 offen
    buffer_load_dwordx4 v[52:55], v105, s[4:7], s34 offen
    v_perm_b32 v67, v60, v56, s28
    v_perm_b32 v71, v60, v56, s29
    v_perm_b32 v75, v61, v57, s28
    v_perm_b32 v79, v61, v57, s29
    v_perm_b32 v83, v62, v58, s28
    v_perm_b32 v87, v62, v58, s29
    v_perm_b32 v91, v63, v59, s28
    v_perm_b32 v95, v63, v59, s29
    buffer_load_dwordx4 v[56:59], v106, s[4:7], s34 offen
    buffer_load_dwordx4 v[60:63], v107, s[4:7], s34 offen
    s_branch L2_pd17
L2_pp16:
    v_perm_b32 v64, v36, v32, s28
    v_perm_b32 v68, v36, v32, s29
    v_perm_b32 v72, v37, v33, s28
    v_perm_b32 v76, v37, v33, s29
    v_perm_b32 v80, v38, v34, s28
    v_perm_b32 v84, v38, v34, s29
    v_perm_b32 v88, v39, v35, s28
    v_perm_b32 v92, v39, v35, s29
    v_perm_b32 v65, v44, v40, s28
    v_perm_b32 v69, v44, v40, s29
    v_perm_b32 v73, v45, v41, s28
    v_perm_b32 v77, v45, v41, s29
    v_perm_b32 v81, v46, v42, s28
    v_perm_b32 v85, v46, v42, s29
    v_perm_b32 v89, v47, v43, s28
    v_perm_b32 v93, v47, v43, s29
    v_perm_b32 v66, v52, v48, s28
    v_perm_b32 v70, v52, v48, s29
    v_perm_b32 v74, v53, v49, s28
    v_perm_b32 v78, v53, v49, s29
    v_perm_b32 v82, v54, v50, s28
    v_perm_b32 v86, v54, v50, s29
    v_perm_b32 v90, v55, v51, s28
    v_perm_b32 v94, v55, v51, s29
    v_perm_b32 v67, v60, v56, s28
    v_perm_b32 v71, v60, v56, s29
    v_perm_b32 v75, v61, v57, s28
    v_perm_b32 v79, v61, v57, s29
    v_perm_b32 v83, v62, v58, s28
    v_perm_b32 v87, v62, v58, s29
    v_perm_b32 v91, v63, v59, s28
    v_perm_b32 v95, v63, v59, s29
    s_cmp_le_u32 s36, 0
    s_cbranch_scc1 L2_pd17
    buffer_load_dwordx4 v[32:35], v100, s[4:7], s34 offen
    s_cmp_le_u32 s36, 4
    s_cbranch_scc1 L2_pd17
    buffer_load_dwordx4 v[36:39], v101, s[4:7], s34 offen
    s_cmp_le_u32 s36, 8
    s_cbranch_scc1 L2_pd17
    buffer_load_dwordx4 v[40:43], v102, s[4:7], s34 offen
    s_cmp_le_u32 s36, 12
    s_cbranch_scc1 L2_pd17
    buffer_load_dwordx4 v[44:47], v103, s[4:7], s34 offen
    s_cmp_le_u32 s36, 16
    s_cbranch_scc1 L2_pd17
    buffer_load_dwordx4 v[48:51], v104, s[4:7], s34 offen
    s_cmp_le_u32 s36, 20
    s_cbranch_scc1 L2_pd17
    buffer_load_dwordx4 v[52:55], v105, s[4:7], s34 offen
    s_cmp_le_u32 s36, 24
    s_cbranch_scc1 L2_pd17
    buffer_load_dwordx4 v[56:59], v106, s[4:7], s34 offen
L2_pd17:
    s_waitcnt lgkmcnt(0)
    s_cmp_eq_u32 s40, 0
    s_cbranch_scc1 L2_XN_acc
    v_mfma_f32_16x16x32_bf16 v[0:3], v[96:99], v[64:67], 0
    v_mfma_f32_16x16x32_bf16 v[4:7], v[96:99], v[68:71], 0
    v_mfma_f32_16x16x32_bf16 v[8:11], v[96:99], v[72:75], 0
    v_mfma_f32_16x16x32_bf16 v[12:15], v[96:99], v[76:79], 0
    v_mfma_f32_16x16x32_bf16 v[16:19], v[96:99], v[80:83], 0
    v_mfma_f32_16x16x32_bf16 v[20:23], v[96:99], v[84:87], 0
    v_mfma_f32_16x16x32_bf16 v[24:27], v[96:99], v[88:91], 0
    v_mfma_f32_16x16x32_bf16 v[28:31], v[96:99], v[92:95], 0
    s_branch L2_XN_epi
L2_XN_acc:
    v_mfma_f32_16x16x32_bf16 v[0:3], v[96:99], v[64:67], v[0:3]
    v_mfma_f32_16x16x32_bf16 v[4:7], v[96:99], v[68:71], v[4:7]
    v_mfma_f32_16x16x32_bf16 v[8:11], v[96:99], v[72:75], v[8:11]
    v_mfma_f32_16x16x32_bf16 v[12:15], v[96:99], v[76:79], v[12:15]
    v_mfma_f32_16x16x32_bf16 v[16:19], v[96:99], v[80:83], v[16:19]
    v_mfma_f32_16x16x32_bf16 v[20:23], v[96:99], v[84:87], v[20:23]
    v_mfma_f32_16x16x32_bf16 v[24:27], v[96:99], v[88:91], v[24:27]
    v_mfma_f32_16x16x32_bf16 v[28:31], v[96:99], v[92:95], v[28:31]
    s_branch L2_XN_epi
L2_XN_k16:
    s_waitcnt vmcnt(0)
    v_perm_b32 v64, v36, v32, s28
    v_perm_b32 v66, v36, v32, s29
    v_perm_b32 v68, v37, v33, s28
    v_perm_b32 v70, v37, v33, s29
    v_perm_b32 v72, v38, v34, s28
    v_perm_b32 v74, v38, v34, s29
    v_perm_b32 v76, v39, v35, s28
    v_perm_b32 v78, v39, v35, s29
    v_perm_b32 v65, v44, v40, s28
    v_perm_b32 v67, v44, v40, s29
    v_perm_b32 v69, v45, v41, s28
    v_perm_b32 v71, v45, v41, s29
    v_perm_b32 v73, v46, v42, s28
    v_perm_b32 v75, v46, v42, s29
    v_perm_b32 v77, v47, v43, s28
    v_perm_b32 v79, v47, v43, s29
    s_cmp_le_u32 s36, 28
    s_cbranch_scc1 L2_XN_k16p
    buffer_load_dwordx4 v[32:35], v100, s[4:7], s34 offen
    buffer_load_dwordx4 v[36:39], v101, s[4:7], s34 offen
    buffer_load_dwordx4 v[40:43], v102, s[4:7], s34 offen
    buffer_load_dwordx4 v[44:47], v103, s[4:7], s34 offen
    buffer_load_dwordx4 v[48:51], v104, s[4:7], s34 offen
    buffer_load_dwordx4 v[52:55], v105, s[4:7], s34 offen
    buffer_load_dwordx4 v[56:59], v106, s[4:7], s34 offen
    buffer_load_dwordx4 v[60:63], v107, s[4:7], s34 offen
    s_branch L2_XN_k16d
L2_XN_k16p:
    s_cmp_le_u32 s36, 0
    s_cbranch_scc1 L2_XN_k16d
    buffer_load_dwordx4 v[32:35], v100, s[4:7], s34 offen
    s_cmp_le_u32 s36, 4
    s_cbranch_scc1 L2_XN_k16d
    buffer_load_dwordx4 v[36:39], v101, s[4:7], s34 offen
    s_cmp_le_u32 s36, 8
    s_cbranch_scc1 L2_XN_k16d
    buffer_load_dwordx4 v[40:43], v102, s[4:7], s34 offen
    s_cmp_le_u32 s36, 12
    s_cbranch_scc1 L2_XN_k16d
    buffer_load_dwordx4 v[44:47], v103, s[4:7], s34 offen
    s_cmp_le_u32 s36, 16
    s_cbranch_scc1 L2_XN_k16d
    buffer_load_dwordx4 v[48:51], v104, s[4:7], s34 offen
    s_cmp_le_u32 s36, 20
    s_cbranch_scc1 L2_XN_k16d
    buffer_load_dwordx4 v[52:55], v105, s[4:7], s34 offen
    s_cmp_le_u32 s36, 24
    s_cbranch_scc1 L2_XN_k16d
    buffer_load_dwordx4 v[56:59], v106, s[4:7], s34 offen
L2_XN_k16d:
    s_waitcnt lgkmcnt(0)
    s_cmp_eq_u32 s40, 0
    s_cbranch_scc1 L2_XN_k16acc
    v_mfma_f32_16x16x16_bf16 v[0:3], v[96:97], v[64:65], 0
    v_mfma_f32_16x16x16_bf16 v[4:7], v[96:97], v[66:67], 0
    v_mfma_f32_16x16x16_bf16 v[8:11], v[96:97], v[68:69], 0
    v_mfma_f32_16x16x16_bf16 v[12:15], v[96:97], v[70:71], 0
    v_mfma_f32_16x16x16_bf16 v[16:19], v[96:97], v[72:73], 0
    v_mfma_f32_16x16x16_bf16 v[20:23], v[96:97], v[74:75], 0
    v_mfma_f32_16x16x16_bf16 v[24:27], v[96:97], v[76:77], 0
    v_mfma_f32_16x16x16_bf16 v[28:31], v[96:97], v[78:79], 0
    s_branch L2_XN_epi
L2_XN_k16acc:
    v_mfma_f32_16x16x16_bf16 v[0:3], v[96:97], v[64:65], v[0:3]
    v_mfma_f32_16x16x16_bf16 v[4:7], v[96:97], v[66:67], v[4:7]
    v_mfma_f32_16x16x16_bf16 v[8:11], v[96:97], v[68:69], v[8:11]
    v_mfma_f32_16x16x16_bf16 v[12:15], v[96:97], v[70:71], v[12:15]
    v_mfma_f32_16x16x16_bf16 v[16:19], v[96:97], v[72:73], v[16:19]
    v_mfma_f32_16x16x16_bf16 v[20:23], v[96:97], v[74:75], v[20:23]
    v_mfma_f32_16x16x16_bf16 v[24:27], v[96:97], v[76:77], v[24:27]
    v_mfma_f32_16x16x16_bf16 v[28:31], v[96:97], v[78:79], v[28:31]
L2_XN_epi:
    s_lshl_b32 s42, s39, 5
    v_add_u32 v119, s42, v117
    ds_read_b128 v[64:67], v119 offset:0
    ds_read_b128 v[68:71], v119 offset:1024
    ds_read_b128 v[72:75], v119 offset:2048
    ds_read_b128 v[76:79], v119 offset:3072
    ds_read_b128 v[80:83], v119 offset:4096
    ds_read_b128 v[84:87], v119 offset:5120
    ds_read_b128 v[88:91], v119 offset:6144
    ds_read_b128 v[92:95], v119 offset:7168
    s_lshr_b32 s43, s38, 4
    s_lshl_b32 s43, s43, 2
    s_cmp_eq_u32 s39, 0
    s_cbranch_scc1 L2_nowar
    v_mov_b32 v120, s43
    s_mov_b32 s45, 0
L_spwar:
    ds_read_b32 v119, v120 offset:832
    s_waitcnt lgkmcnt(0)
    v_readfirstlane_b32 s44, v119
    s_add_u32 s45, s45, 1
    s_cmp_ge_u32 s44, 4
    s_cbranch_scc1 L_spwar_ok
    s_cmp_lt_u32 s45, 0x400000
    s_cbranch_scc1 L_spwar
L_spwar_ok:
    s_add_u32 s43, s43, 16
L2_nowar:
    s_and_b32 s44, s38, 15
    s_lshl_b32 s44, s44, 4
    s_and_b32 s45, s38, 63
    s_lshl_b32 s45, s45, 10
    s_add_u32 s45, s45, 64768
    v_xor_b32 v119, s44, v118
    v_add_u32 v119, s45, v119
    v_mov_b32 v120, s43
    s_waitcnt lgkmcnt(0)
    v_mul_f32 v64, v64, v0
    v_mul_f32 v68, v68, v4
    v_mul_f32 v72, v72, v8
    v_mul_f32 v76, v76, v12
    v_mul_f32 v80, v80, v16
    v_mul_f32 v84, v84, v20
    v_mul_f32 v88, v88, v24
    v_mul_f32 v92, v92, v28
    v_fmac_f32 v64, v65, v1
    v_fmac_f32 v68, v69, v5
    v_fmac_f32 v72, v73, v9
    v_fmac_f32 v76, v77, v13
    v_fmac_f32 v80, v81, v17
    v_fmac_f32 v84, v85, v21
    v_fmac_f32 v88, v89, v25
    v_fmac_f32 v92, v93, v29
    v_fmac_f32 v64, v66, v2
    v_fmac_f32 v68, v70, v6
    v_fmac_f32 v72, v74, v10
    v_fmac_f32 v76, v78, v14
    v_fmac_f32 v80, v82, v18
    v_fmac_f32 v84, v86, v22
    v_fmac_f32 v88, v90, v26
    v_fmac_f32 v92, v94, v30
    v_fmac_f32 v64, v67, v3
    v_fmac_f32 v68, v71, v7
    v_fmac_f32 v72, v75, v11
    v_fmac_f32 v76, v79, v15
    v_fmac_f32 v80, v83, v19
    v_fmac_f32 v84, v87, v23
    v_fmac_f32 v88, v91, v27
    v_fmac_f32 v92, v95, v31
    v_cvt_pk_bf16_f32 v96, v64, v68
    v_cvt_pk_bf16_f32 v97, v72, v76
    v_cvt_pk_bf16_f32 v98, v80, v84
    v_cvt_pk_bf16_f32 v99, v88, v92
    ds_write_b128 v119, v[96:99]
    s_mov_b64 exec, 1
    ds_add_u32 v120, v121 offset:784
    s_mov_b64 exec, -1
    s_cmp_lg_u32 s37, 0
    s_cbranch_scc1 L2_A1
L2_g_done:
    s_cmp_lg_u32 s24, 0
    s_cbranch_scc1 L2_g_exit
    s_add_u32 s89, s89, 1
    s_branch L2_g_slow
L2_g_overflow:
    s_mov_b32 s89, 0
    s_mov_b32 s23, 1
    s_movk_i32 s48, 64
L2_g_slow:
    s_waitcnt vmcnt(0) lgkmcnt(0)
    s_barrier
    s_lshr_b32 s22, s89, 1
    s_and_b32 s88, s89, 1
    s_lshl_b32 s88, s88, 8
    s_add_u32 s88, s88, s20
    s_cmp_eq_u32 s89, 499
    s_cselect_b32 s24, 1, 0
    s_barrier
    s_branch L2_g_round
L2_g_exit:
    s_endpgm
L2_gemm:
    v_and_b32 v104, 63, v0
    v_lshlrev_b32 v105, 4, v104
    s_mov_b32 s44, 3289527088
    s_mov_b32 s45, 474104258
    v_lshrrev_b32 v106, 4, v104
    v_bfe_u32 v107, v104, 3, 1
    v_lshl_add_u32 v106, v106, 2, v107
    v_add_lshl_u32 v106, v106, 0, 2
    v_lshrrev_b64 v[108:109], v106, s[44:45]
    v_and_b32 v106, 7, v108
    v_and_b32 v110, 8, v108
    v_lshlrev_b32 v110, 28, v110
    v_and_b32 v107, 7, v104
    v_lshlrev_b32 v107, 3, v107
    v_lshl_add_u32 v106, v106, 6, v107
    v_add_u32 v106, s21, v106
    v_lshlrev_b32 v112, 1, v106
    v_lshrrev_b32 v106, 4, v104
    v_bfe_u32 v107, v104, 3, 1
    v_lshl_add_u32 v106, v106, 2, v107
    v_add_lshl_u32 v106, v106, 2, 2
    v_lshrrev_b64 v[108:109], v106, s[44:45]
    v_and_b32 v106, 7, v108
    v_and_b32 v111, 8, v108
    v_lshlrev_b32 v111, 28, v111
    v_and_b32 v107, 7, v104
    v_lshlrev_b32 v107, 3, v107
    v_lshl_add_u32 v106, v106, 6, v107
    v_add_u32 v106, s21, v106
    v_lshlrev_b32 v113, 1, v106
    v_mov_b32 v117, v0
    s_waitcnt vmcnt(0)
    s_barrier
    s_cmp_ge_u32 s21, s25
    s_cbranch_scc1 L_noearlym
    buffer_store_dwordx4 v[100:103], v1, s[8:11], s49 offen sc1
L_noearlym:
    buffer_store_dwordx4 v[16:19], v3, s[8:11], s51 offen sc1
    s_not_b64 exec, s[54:55]
    s_cbranch_execz L_stskipm0
    buffer_store_dwordx4 v[12:15], v2, s[8:11], s51 offen sc1
L_stskipm0:
    s_mov_b64 exec, s[92:93]
    s_cbranch_execz L_stskipm1
    buffer_store_dwordx4 v[20:23], v24, s[8:11], s51 offen sc1
L_stskipm1:
    s_not_b64 exec, s[52:53]
    s_cbranch_execz L_stskipm2
    buffer_store_dwordx4 v[8:11], v1, s[8:11], s51 offen sc1
L_stskipm2:
    s_mov_b64 exec, -1
    s_waitcnt vmcnt(0) lgkmcnt(0)
    s_barrier
    s_cmp_lt_u32 s21, s25
    s_cbranch_scc1 L_nolatem
    buffer_store_dwordx4 v[100:103], v1, s[8:11], s49 offen sc1
L_nolatem:
    buffer_load_ushort v80, v112, s[16:19], 0 offen offset:0
    buffer_load_ushort v81, v112, s[16:19], 0 offen offset:640
    buffer_load_ushort v82, v112, s[16:19], 0 offen offset:1280
    buffer_load_ushort v83, v112, s[16:19], 0 offen offset:1920
    buffer_load_ushort v84, v112, s[16:19], 0 offen offset:8
    buffer_load_ushort v85, v112, s[16:19], 0 offen offset:648
    buffer_load_ushort v86, v112, s[16:19], 0 offen offset:1288
    buffer_load_ushort v87, v112, s[16:19], 0 offen offset:1928
    buffer_load_ushort v88, v113, s[16:19], 0 offen offset:0
    buffer_load_ushort v89, v113, s[16:19], 0 offen offset:640
    buffer_load_ushort v90, v113, s[16:19], 0 offen offset:1280
    buffer_load_ushort v91, v113, s[16:19], 0 offen offset:1920
    buffer_load_ushort v92, v113, s[16:19], 0 offen offset:8
    buffer_load_ushort v93, v113, s[16:19], 0 offen offset:648
    buffer_load_ushort v94, v113, s[16:19], 0 offen offset:1288
    buffer_load_ushort v95, v113, s[16:19], 0 offen offset:1928
    v_lshrrev_b32 v106, 4, v104
    v_lshlrev_b32 v106, 10, v106
    v_bfe_u32 v107, v104, 2, 2
    v_lshl_add_u32 v106, v107, 7, v106
    v_and_b32 v107, 3, v104
    v_lshl_add_u32 v106, v107, 3, v106
    s_lshl_b32 s42, s21, 5
    s_add_u32 s42, s42, 64768
    v_add_u32 v106, s42, v106
    ds_read_b64_tr_b16 v[0:1], v106 offset:0
    ds_read_b64_tr_b16 v[2:3], v106 offset:512
    ds_read_b64_tr_b16 v[4:5], v106 offset:4096
    ds_read_b64_tr_b16 v[6:7], v106 offset:4608
    ds_read_b64_tr_b16 v[8:9], v106 offset:8192
    ds_read_b64_tr_b16 v[10:11], v106 offset:8704
    ds_read_b64_tr_b16 v[12:13], v106 offset:12288
    ds_read_b64_tr_b16 v[14:15], v106 offset:12800
    ds_read_b64_tr_b16 v[16:17], v106 offset:16384
    ds_read_b64_tr_b16 v[18:19], v106 offset:16896
    ds_read_b64_tr_b16 v[20:21], v106 offset:20480
    ds_read_b64_tr_b16 v[22:23], v106 offset:20992
    ds_read_b64_tr_b16 v[24:25], v106 offset:24576
    ds_read_b64_tr_b16 v[26:27], v106 offset:25088
    ds_read_b64_tr_b16 v[28:29], v106 offset:28672
    ds_read_b64_tr_b16 v[30:31], v106 offset:29184
    ds_read_b64_tr_b16 v[32:33], v106 offset:32768
    ds_read_b64_tr_b16 v[34:35], v106 offset:33280
    ds_read_b64_tr_b16 v[36:37], v106 offset:36864
    ds_read_b64_tr_b16 v[38:39], v106 offset:37376
    s_lshl_b32 s42, s21, 10
    s_add_u32 s43, s42, 115968
    v_add_u32 v105, s43, v105
    s_waitcnt vmcnt(0)
    v_lshlrev_b32 v80, 16, v80
    v_xor_b32 v80, v110, v80
    v_lshlrev_b32 v81, 16, v81
    v_xor_b32 v81, v110, v81
    v_lshlrev_b32 v82, 16, v82
    v_xor_b32 v82, v110, v82
    v_lshlrev_b32 v83, 16, v83
    v_xor_b32 v83, v110, v83
    ds_write_b128 v105, v[80:83] offset:0
    v_lshlrev_b32 v84, 16, v84
    v_xor_b32 v84, v110, v84
    v_lshlrev_b32 v85, 16, v85
    v_xor_b32 v85, v110, v85
    v_lshlrev_b32 v86, 16, v86
    v_xor_b32 v86, v110, v86
    v_lshlrev_b32 v87, 16, v87
    v_xor_b32 v87, v110, v87
    ds_write_b128 v105, v[84:87] offset:4096
    v_lshlrev_b32 v88, 16, v88
    v_xor_b32 v88, v111, v88
    v_lshlrev_b32 v89, 16, v89
    v_xor_b32 v89, v111, v89
    v_lshlrev_b32 v90, 16, v90
    v_xor_b32 v90, v111, v90
    v_lshlrev_b32 v91, 16, v91
    v_xor_b32 v91, v111, v91
    ds_write_b128 v105, v[88:91] offset:8192
    v_lshlrev_b32 v92, 16, v92
    v_xor_b32 v92, v111, v92
    v_lshlrev_b32 v93, 16, v93
    v_xor_b32 v93, v111, v93
    v_lshlrev_b32 v94, 16, v94
    v_xor_b32 v94, v111, v94
    v_lshlrev_b32 v95, 16, v95
    v_xor_b32 v95, v111, v95
    ds_write_b128 v105, v[92:95] offset:12288
    v_and_b32 v106, 15, v104
    v_lshrrev_b32 v107, 4, v104
    v_lshlrev_b32 v124, 2, v104
    s_mul_i32 s42, s20, 25
    s_movk_i32 s44, 25
    s_lshl_b32 s42, s42, 9
    s_mov_b32 s40, s42
    s_mov_b32 s41, s44
    s_lshl_b32 s43, s21, 5
    s_add_u32 s42, s42, s43
    v_lshlrev_b32 v125, 9, v106
    v_lshl_add_u32 v125, v107, 3, v125
    v_add_u32 v125, s42, v125
    v_cmp_le_u32 s[84:85], 9, v106
    s_sub_u32 s43, s44, 23
    v_cmp_gt_i32 s[50:51], s43, v106
    s_sub_u32 s43, s44, 16
    v_cmp_gt_i32 s[94:95], s43, v106
    v_lshlrev_b32 v108, 10, v106
    v_add_u32 v108, 64768, v108
    s_or_b64 s[94:95], s[94:95], s[84:85]
    v_add_u32 v109, 12, v107
    v_xor_b32 v109, v109, v106
    v_lshl_add_u32 v115, v109, 4, v108
    v_add_u32 v109, 8, v107
    v_xor_b32 v109, v109, v106
    v_lshl_add_u32 v114, v109, 4, v108
    v_add_u32 v109, 4, v107
    v_xor_b32 v109, v109, v106
    v_lshl_add_u32 v113, v109, 4, v108
    v_add_u32 v109, 0, v107
    v_xor_b32 v109, v109, v106
    v_lshl_add_u32 v112, v109, 4, v108
    s_waitcnt lgkmcnt(0)
    v_mov_b32 v104, v112
    v_mov_b32 v105, v113
    v_mov_b32 v106, v114
    v_mov_b32 v107, v115
    s_mov_b32 s89, 0
    v_lshrrev_b32 v99, 2, v124
    s_lshl_b32 s42, s21, 11
    v_lshl_add_u32 v64, v99, 4, s42
    v_lshrrev_b32 v100, 1, v99
    s_lshl_b32 s43, s21, 5
    s_sub_u32 s44, 122, s43
    v_cmp_gt_i32 s[46:47], s44, v100
    s_mov_b32 s44, 70784
    v_mul_u32_u24 v100, s44, v100
    v_and_b32 v101, 16, v64
    v_add_u32 v65, v100, v101
    v_cndmask_b32 v66, 2.0, v65, s[46:47]
    v_and_b32 v96, 7, v99
    v_lshrrev_b32 v100, 3, v99
    v_mul_u32_u24 v97, s44, v100
    v_lshl_add_u32 v80, v100, 5, s42
    s_mul_i32 s38, s43, s44
    v_add_u32 v97, s38, v97
    v_mov_b32 v98, 1
    s_lshl_b32 s36, s20, 5
    s_add_u32 s36, s36, 59392
    s_add_u32 s36, s36, s38
    s_add_u32 s37, s36, 9060352
    s_lshl_b32 s42, s21, 6
    v_add_u32 v99, s42, v99
    v_mul_u32_u24 v100, 0xaab, v99
    v_lshrrev_b32 v100, 16, v100
    v_mul_u32_u24 v100, 1600, v100
    v_lshl_add_u32 v67, v99, 5, v100
    v_add_u32 v67, 132380, v67
    s_movk_i32 s42, 250
    v_cmp_gt_u32 s[92:93], s42, v99
L2_m_round:
    s_barrier
    s_cmp_eq_u32 s23, 1
    s_cbranch_scc1 L2_m_slowC
    ds_read_b32 v108, v124 offset:0
    ds_read_b32 v109, v124 offset:256
    ds_read_b32 v99, v67
    s_waitcnt lgkmcnt(0)
    v_add_u32 v108, v108, v109
    v_and_b32 v99, 0xfff, v99
    v_cndmask_b32 v99, 0, v99, s[92:93]
    v_add_u32_dpp v108, v108, v108 row_shr:1 row_mask:0xf bank_mask:0xf
    s_nop 1
    v_add_u32_dpp v108, v108, v108 row_shr:2 row_mask:0xf bank_mask:0xf
    s_nop 1
    v_add_u32_dpp v108, v108, v108 row_shr:4 row_mask:0xf bank_mask:0xf
    s_nop 1
    v_add_u32_dpp v108, v108, v108 row_shr:8 row_mask:0xf bank_mask:0xf
    s_nop 1
    v_add_u32_dpp v108, v108, v108 row_bcast:15 row_mask:0xa bank_mask:0xf
    s_nop 1
    v_add_u32_dpp v108, v108, v108 row_bcast:31 row_mask:0xc bank_mask:0xf
    v_add_u32_dpp v99, v99, v99 row_shr:1 row_mask:0xf bank_mask:0xf
    s_nop 1
    v_add_u32_dpp v99, v99, v99 row_shr:2 row_mask:0xf bank_mask:0xf
    s_nop 1
    v_add_u32_dpp v99, v99, v99 row_shr:4 row_mask:0xf bank_mask:0xf
    s_nop 1
    v_add_u32_dpp v99, v99, v99 row_shr:8 row_mask:0xf bank_mask:0xf
    s_nop 1
    v_add_u32_dpp v99, v99, v99 row_bcast:15 row_mask:0xa bank_mask:0xf
    s_nop 1
    v_add_u32_dpp v99, v99, v99 row_bcast:31 row_mask:0xc bank_mask:0xf
    v_readlane_b32 s42, v108, 63
    v_mov_b32 v101, 0
    s_mov_b32 exec_lo, 0
    s_mov_b32 exec_hi, 0x80000000
    ds_add_u32 v101, v99 offset:872
    s_mov_b64 exec, -1
    s_cmp_gt_u32 s42, 1888
    s_cbranch_scc1 L2_m_overflow
    buffer_load_dwordx4 v[112:115], v65, s[8:11], s36 offen sc1
    buffer_load_dwordx4 v[116:119], v66, s[8:11], s37 offen sc1
    s_waitcnt lgkmcnt(0)
    s_barrier
    ds_read_b32 v99, v101 offset:872
    s_mov_b32 s44, 0
    s_waitcnt lgkmcnt(0)
    v_readfirstlane_b32 s42, v99
    v_or_b32 v103, 0x0c0c0c00, v96
    s_cmp_gt_u32 s42, 1888
    s_cbranch_scc1 L2_m_overflow
    s_mov_b32 s34, s42
    s_branch L2_pollB_w
L2_pollB:
    buffer_load_dwordx4 v[112:115], v65, s[8:11], s36 offen sc1
    buffer_load_dwordx4 v[116:119], v66, s[8:11], s37 offen sc1
L2_pollB_w:
    s_add_u32 s44, s44, 1
    s_waitcnt vmcnt(0)
    v_xor_b32 v100, s87, v112
    v_xor_b32 v99, s86, v113
    v_lshrrev_b32 v100, 24, v100
    v_or_b32 v99, v99, v100
    v_xor_b32 v100, s3, v115
    v_lshrrev_b32 v100, 12, v100
    v_cndmask_b32 v99, v99, v100, s[26:27]
    v_xor_b32 v100, s87, v116
    v_xor_b32 v101, s86, v117
    v_lshrrev_b32 v100, 24, v100
    v_or_b32 v101, v101, v100
    v_xor_b32 v100, s3, v119
    v_lshrrev_b32 v100, 12, v100
    v_cndmask_b32 v101, v101, v100, s[26:27]
    v_cndmask_b32 v101, 0, v101, s[46:47]
    v_or_b32 v99, v99, v101
    v_cmp_ne_u32 vcc, 0, v99
    s_nop 1
    s_cmp_eq_u64 vcc, 0
    s_cbranch_scc1 L2_pollB_ok
    s_sleep 2
    s_cmp_lt_u32 s44, 0x100000
    s_cbranch_scc1 L2_pollB
L2_pollB_ok:
    ds_write_b128 v64, v[112:115] offset:33408
    ds_write_b128 v64, v[116:119] offset:34432
    ds_read_b128 v[108:111], v80 offset:33408
    ds_read_b64 v[112:113], v80 offset:33424
    ds_read_b128 v[116:119], v80 offset:33664
    ds_read_b64 v[120:121], v80 offset:33680
    v_add_u32 v100, 8, v96
    s_waitcnt lgkmcnt(2)
    v_and_b32 v56, 0xfff, v108
    v_bfe_u32 v40, v108, 12, 12
    v_perm_b32 v64, v111, v110, v103
    v_perm_b32 v65, v113, v112, v103
    ds_read_b128 v[108:111], v80 offset:33920
    ds_read_b64 v[112:113], v80 offset:33936
    v_add_u32 v56, v56, v96
    v_cmp_lt_u32 s[52:53], v96, v40
    v_cmp_lt_u32 s[54:55], v100, v40
    v_lshl_add_u32 v56, v56, 4, v97
    s_waitcnt lgkmcnt(2)
    v_and_b32 v57, 0xfff, v116
    v_bfe_u32 v41, v116, 12, 12
    v_perm_b32 v66, v119, v118, v103
    v_perm_b32 v67, v121, v120, v103
    ds_read_b128 v[116:119], v80 offset:34176
    ds_read_b64 v[120:121], v80 offset:34192
    v_add_u32 v57, v57, v96
    v_cmp_lt_u32 s[56:57], v96, v41
    v_cmp_lt_u32 s[58:59], v100, v41
    v_lshl_add_u32 v57, v57, 4, v97
    s_waitcnt lgkmcnt(2)
    v_and_b32 v58, 0xfff, v108
    v_bfe_u32 v42, v108, 12, 12
    v_perm_b32 v68, v111, v110, v103
    v_perm_b32 v69, v113, v112, v103
    ds_read_b128 v[108:111], v80 offset:34432
    ds_read_b64 v[112:113], v80 offset:34448
    v_add_u32 v58, v58, v96
    v_cmp_lt_u32 s[60:61], v96, v42
    v_cmp_lt_u32 s[62:63], v100, v42
    v_lshl_add_u32 v58, v58, 4, v97
    s_waitcnt lgkmcnt(2)
    v_and_b32 v59, 0xfff, v116
    v_bfe_u32 v43, v116, 12, 12
    v_perm_b32 v70, v119, v118, v103
    v_perm_b32 v71, v121, v120, v103
    ds_read_b128 v[116:119], v80 offset:34688
    ds_read_b64 v[120:121], v80 offset:34704
    v_add_u32 v59, v59, v96
    v_cmp_lt_u32 s[64:65], v96, v43
    v_cmp_lt_u32 s[66:67], v100, v43
    v_lshl_add_u32 v59, v59, 4, v97
    s_waitcnt lgkmcnt(2)
    v_and_b32 v60, 0xfff, v108
    v_bfe_u32 v44, v108, 12, 12
    v_perm_b32 v72, v111, v110, v103
    v_perm_b32 v73, v113, v112, v103
    ds_read_b128 v[108:111], v80 offset:34944
    ds_read_b64 v[112:113], v80 offset:34960
    v_add_u32 v60, v60, v96
    v_cmp_lt_u32 s[68:69], v96, v44
    v_cmp_lt_u32 s[70:71], v100, v44
    v_lshl_add_u32 v60, v60, 4, v97
    s_waitcnt lgkmcnt(2)
    v_and_b32 v61, 0xfff, v116
    v_bfe_u32 v45, v116, 12, 12
    v_perm_b32 v74, v119, v118, v103
    v_perm_b32 v75, v121, v120, v103
    ds_read_b128 v[116:119], v80 offset:35200
    ds_read_b64 v[120:121], v80 offset:35216
    v_add_u32 v61, v61, v96
    v_cmp_lt_u32 s[72:73], v96, v45
    v_cmp_lt_u32 s[74:75], v100, v45
    v_lshl_add_u32 v61, v61, 4, v97
    s_waitcnt lgkmcnt(2)
    v_and_b32 v62, 0xfff, v108
    v_bfe_u32 v46, v108, 12, 12
    v_perm_b32 v76, v111, v110, v103
    v_perm_b32 v77, v113, v112, v103
    v_add_u32 v62, v62, v96
    v_cmp_lt_u32 s[76:77], v96, v46
    v_cmp_lt_u32 s[78:79], v100, v46
    v_lshl_add_u32 v62, v62, 4, v97
    s_waitcnt lgkmcnt(0)
    v_and_b32 v63, 0xfff, v116
    v_bfe_u32 v47, v116, 12, 12
    v_perm_b32 v78, v119, v118, v103
    v_perm_b32 v79, v121, v120, v103
    v_add_u32 v63, v63, v96
    v_cmp_lt_u32 s[80:81], v96, v47
    v_cmp_lt_u32 s[82:83], v100, v47
    v_lshl_add_u32 v63, v63, 4, v97
    s_mov_b32 s42, 0
    s_mov_b64 exec, -1
    v_cndmask_b32 v101, 2.0, v56, s[52:53]
    buffer_load_dwordx4 v[108:111], v101, s[8:11], s42 offen offset:0 sc1
    s_mov_b32 s42, 0
    s_mov_b64 exec, -1
    v_cndmask_b32 v102, 2.0, v56, s[54:55]
    buffer_load_dwordx4 v[112:115], v102, s[8:11], s42 offen offset:128 sc1
    s_mov_b32 s42, 566272
    s_mov_b64 exec, -1
    v_cndmask_b32 v101, 2.0, v57, s[56:57]
    buffer_load_dwordx4 v[116:119], v101, s[8:11], s42 offen offset:0 sc1
    s_mov_b32 s42, 566272
    s_mov_b64 exec, -1
    v_cndmask_b32 v102, 2.0, v57, s[58:59]
    buffer_load_dwordx4 v[120:123], v102, s[8:11], s42 offen offset:128 sc1
    v_max3_u32 v99, v40, v41, v42
    v_max3_u32 v99, v99, v43, v44
    v_max3_u32 v99, v99, v45, v46
    v_max_u32 v99, v99, v47
    v_cmp_lt_u32 vcc, 16, v99
    v_mov_b32 v100, v80
    s_mov_b64 exec, s[52:53]
    ds_add_rtn_u32 v80, v64, v98 offset:1024
    s_mov_b64 exec, s[54:55]
    ds_add_rtn_u32 v81, v65, v98 offset:1024
    s_mov_b64 exec, s[56:57]
    ds_add_rtn_u32 v82, v66, v98 offset:1024
    s_mov_b64 exec, s[58:59]
    ds_add_rtn_u32 v83, v67, v98 offset:1024
    s_mov_b64 exec, s[60:61]
    ds_add_rtn_u32 v84, v68, v98 offset:1024
    s_mov_b64 exec, s[62:63]
    ds_add_rtn_u32 v85, v69, v98 offset:1024
    s_mov_b64 exec, s[64:65]
    ds_add_rtn_u32 v86, v70, v98 offset:1024
    s_mov_b64 exec, s[66:67]
    ds_add_rtn_u32 v87, v71, v98 offset:1024
    s_mov_b64 exec, s[68:69]
    ds_add_rtn_u32 v88, v72, v98 offset:1024
    s_mov_b64 exec, s[70:71]
    ds_add_rtn_u32 v89, v73, v98 offset:1024
    s_mov_b64 exec, s[72:73]
    ds_add_rtn_u32 v90, v74, v98 offset:1024
    s_mov_b64 exec, s[74:75]
    ds_add_rtn_u32 v91, v75, v98 offset:1024
    s_mov_b64 exec, s[76:77]
    ds_add_rtn_u32 v92, v76, v98 offset:1024
    s_mov_b64 exec, s[78:79]
    ds_add_rtn_u32 v93, v77, v98 offset:1024
    s_mov_b64 exec, s[80:81]
    ds_add_rtn_u32 v94, v78, v98 offset:1024
    s_mov_b64 exec, s[82:83]
    ds_add_rtn_u32 v95, v79, v98 offset:1024
    s_mov_b64 exec, -1
    s_cmp_lg_u64 vcc, 0
    s_cselect_b32 s35, 1, 0
    s_cbranch_scc0 L2_bnoxa
    v_min_u32 v101, 20, v40
    v_add_u32 v102, 16, v96
    v_cmp_lt_u32 vcc, v102, v101
    s_and_saveexec_b64 s[44:45], vcc
    s_nop 3
    s_cbranch_execz L2_bw2a0
    ds_read_b32 v48, v100 offset:33432
    s_waitcnt lgkmcnt(0)
    v_perm_b32 v48, v48, v48, v103
    ds_add_rtn_u32 v101, v48, v98 offset:1024
    s_waitcnt lgkmcnt(0)
    v_lshl_or_b32 v48, v101, 8, v48
L2_bw2a0:
    s_mov_b64 exec, -1
    v_min_u32 v101, 20, v41
    v_add_u32 v102, 16, v96
    v_cmp_lt_u32 vcc, v102, v101
    s_and_saveexec_b64 s[44:45], vcc
    s_nop 3
    s_cbranch_execz L2_bw2a1
    ds_read_b32 v49, v100 offset:33688
    s_waitcnt lgkmcnt(0)
    v_perm_b32 v49, v49, v49, v103
    ds_add_rtn_u32 v101, v49, v98 offset:1024
    s_waitcnt lgkmcnt(0)
    v_lshl_or_b32 v49, v101, 8, v49
L2_bw2a1:
    s_mov_b64 exec, -1
    v_min_u32 v101, 20, v42
    v_add_u32 v102, 16, v96
    v_cmp_lt_u32 vcc, v102, v101
    s_and_saveexec_b64 s[44:45], vcc
    s_nop 3
    s_cbranch_execz L2_bw2a2
    ds_read_b32 v50, v100 offset:33944
    s_waitcnt lgkmcnt(0)
    v_perm_b32 v50, v50, v50, v103
    ds_add_rtn_u32 v101, v50, v98 offset:1024
    s_waitcnt lgkmcnt(0)
    v_lshl_or_b32 v50, v101, 8, v50
L2_bw2a2:
    s_mov_b64 exec, -1
    v_min_u32 v101, 20, v43
    v_add_u32 v102, 16, v96
    v_cmp_lt_u32 vcc, v102, v101
    s_and_saveexec_b64 s[44:45], vcc
    s_nop 3
    s_cbranch_execz L2_bw2a3
    ds_read_b32 v51, v100 offset:34200
    s_waitcnt lgkmcnt(0)
    v_perm_b32 v51, v51, v51, v103
    ds_add_rtn_u32 v101, v51, v98 offset:1024
    s_waitcnt lgkmcnt(0)
    v_lshl_or_b32 v51, v101, 8, v51
L2_bw2a3:
    s_mov_b64 exec, -1
    v_min_u32 v101, 20, v44
    v_add_u32 v102, 16, v96
    v_cmp_lt_u32 vcc, v102, v101
    s_and_saveexec_b64 s[44:45], vcc
    s_nop 3
    s_cbranch_execz L2_bw2a4
    ds_read_b32 v52, v100 offset:34456
    s_waitcnt lgkmcnt(0)
    v_perm_b32 v52, v52, v52, v103
    ds_add_rtn_u32 v101, v52, v98 offset:1024
    s_waitcnt lgkmcnt(0)
    v_lshl_or_b32 v52, v101, 8, v52
L2_bw2a4:
    s_mov_b64 exec, -1
    v_min_u32 v101, 20, v45
    v_add_u32 v102, 16, v96
    v_cmp_lt_u32 vcc, v102, v101
    s_and_saveexec_b64 s[44:45], vcc
    s_nop 3
    s_cbranch_execz L2_bw2a5
    ds_read_b32 v53, v100 offset:34712
    s_waitcnt lgkmcnt(0)
    v_perm_b32 v53, v53, v53, v103
    ds_add_rtn_u32 v101, v53, v98 offset:1024
    s_waitcnt lgkmcnt(0)
    v_lshl_or_b32 v53, v101, 8, v53
L2_bw2a5:
    s_mov_b64 exec, -1
    v_min_u32 v101, 20, v46
    v_add_u32 v102, 16, v96
    v_cmp_lt_u32 vcc, v102, v101
    s_and_saveexec_b64 s[44:45], vcc
    s_nop 3
    s_cbranch_execz L2_bw2a6
    ds_read_b32 v54, v100 offset:34968
    s_waitcnt lgkmcnt(0)
    v_perm_b32 v54, v54, v54, v103
    ds_add_rtn_u32 v101, v54, v98 offset:1024
    s_waitcnt lgkmcnt(0)
    v_lshl_or_b32 v54, v101, 8, v54
L2_bw2a6:
    s_mov_b64 exec, -1
    v_min_u32 v101, 20, v47
    v_add_u32 v102, 16, v96
    v_cmp_lt_u32 vcc, v102, v101
    s_and_saveexec_b64 s[44:45], vcc
    s_nop 3
    s_cbranch_execz L2_bw2a7
    ds_read_b32 v55, v100 offset:35224
    s_waitcnt lgkmcnt(0)
    v_perm_b32 v55, v55, v55, v103
    ds_add_rtn_u32 v101, v55, v98 offset:1024
    s_waitcnt lgkmcnt(0)
    v_lshl_or_b32 v55, v101, 8, v55
L2_bw2a7:
    s_mov_b64 exec, -1
    s_mov_b32 s42, 67584
    v_sub_u32 v102, v56, v97
    v_lshrrev_b32 v102, 4, v102
    v_add_u32 v102, v102, v97
    v_add_u32 v99, 20, v96
    v_add_u32 v100, 20, v102
L_xab0:
    v_cmp_lt_u32 vcc, v99, v40
    s_and_saveexec_b64 s[44:45], vcc
    s_nop 3
    s_cbranch_execz L_xab0_done
    buffer_load_ubyte v101, v100, s[8:11], s42 offen sc1
    s_waitcnt vmcnt(0)
    ds_add_u32 v101, v98 offset:1280
    s_mov_b64 exec, -1
    v_add_u32 v99, 8, v99
    v_add_u32 v100, 8, v100
    s_nop 1
    s_branch L_xab0
L_xab0_done:
    s_mov_b64 exec, -1
    s_mov_b32 s42, 633856
    v_sub_u32 v102, v57, v97
    v_lshrrev_b32 v102, 4, v102
    v_add_u32 v102, v102, v97
    v_add_u32 v99, 20, v96
    v_add_u32 v100, 20, v102
L_xab1:
    v_cmp_lt_u32 vcc, v99, v41
    s_and_saveexec_b64 s[44:45], vcc
    s_nop 3
    s_cbranch_execz L_xab1_done
    buffer_load_ubyte v101, v100, s[8:11], s42 offen sc1
    s_waitcnt vmcnt(0)
    ds_add_u32 v101, v98 offset:1280
    s_mov_b64 exec, -1
    v_add_u32 v99, 8, v99
    v_add_u32 v100, 8, v100
    s_nop 1
    s_branch L_xab1
L_xab1_done:
    s_mov_b64 exec, -1
    s_mov_b32 s42, 1200128
    v_sub_u32 v102, v58, v97
    v_lshrrev_b32 v102, 4, v102
    v_add_u32 v102, v102, v97
    v_add_u32 v99, 20, v96
    v_add_u32 v100, 20, v102
L_xab2:
    v_cmp_lt_u32 vcc, v99, v42
    s_and_saveexec_b64 s[44:45], vcc
    s_nop 3
    s_cbranch_execz L_xab2_done
    buffer_load_ubyte v101, v100, s[8:11], s42 offen sc1
    s_waitcnt vmcnt(0)
    ds_add_u32 v101, v98 offset:1280
    s_mov_b64 exec, -1
    v_add_u32 v99, 8, v99
    v_add_u32 v100, 8, v100
    s_nop 1
    s_branch L_xab2
L_xab2_done:
    s_mov_b64 exec, -1
    s_mov_b32 s42, 1766400
    v_sub_u32 v102, v59, v97
    v_lshrrev_b32 v102, 4, v102
    v_add_u32 v102, v102, v97
    v_add_u32 v99, 20, v96
    v_add_u32 v100, 20, v102
L_xab3:
    v_cmp_lt_u32 vcc, v99, v43
    s_and_saveexec_b64 s[44:45], vcc
    s_nop 3
    s_cbranch_execz L_xab3_done
    buffer_load_ubyte v101, v100, s[8:11], s42 offen sc1
    s_waitcnt vmcnt(0)
    ds_add_u32 v101, v98 offset:1280
    s_mov_b64 exec, -1
    v_add_u32 v99, 8, v99
    v_add_u32 v100, 8, v100
    s_nop 1
    s_branch L_xab3
L_xab3_done:
    s_mov_b64 exec, -1
    s_mov_b32 s42, 9127936
    v_sub_u32 v102, v60, v97
    v_lshrrev_b32 v102, 4, v102
    v_add_u32 v102, v102, v97
    v_add_u32 v99, 20, v96
    v_add_u32 v100, 20, v102
L_xab4:
    v_cmp_lt_u32 vcc, v99, v44
    s_and_saveexec_b64 s[44:45], vcc
    s_nop 3
    s_cbranch_execz L_xab4_done
    buffer_load_ubyte v101, v100, s[8:11], s42 offen sc1
    s_waitcnt vmcnt(0)
    ds_add_u32 v101, v98 offset:1280
    s_mov_b64 exec, -1
    v_add_u32 v99, 8, v99
    v_add_u32 v100, 8, v100
    s_nop 1
    s_branch L_xab4
L_xab4_done:
    s_mov_b64 exec, -1
    s_mov_b32 s42, 9694208
    v_sub_u32 v102, v61, v97
    v_lshrrev_b32 v102, 4, v102
    v_add_u32 v102, v102, v97
    v_add_u32 v99, 20, v96
    v_add_u32 v100, 20, v102
L_xab5:
    v_cmp_lt_u32 vcc, v99, v45
    s_and_saveexec_b64 s[44:45], vcc
    s_nop 3
    s_cbranch_execz L_xab5_done
    buffer_load_ubyte v101, v100, s[8:11], s42 offen sc1
    s_waitcnt vmcnt(0)
    ds_add_u32 v101, v98 offset:1280
    s_mov_b64 exec, -1
    v_add_u32 v99, 8, v99
    v_add_u32 v100, 8, v100
    s_nop 1
    s_branch L_xab5
L_xab5_done:
    s_mov_b64 exec, -1
    s_mov_b32 s42, 10260480
    v_sub_u32 v102, v62, v97
    v_lshrrev_b32 v102, 4, v102
    v_add_u32 v102, v102, v97
    v_add_u32 v99, 20, v96
    v_add_u32 v100, 20, v102
L_xab6:
    v_cmp_lt_u32 vcc, v99, v46
    s_and_saveexec_b64 s[44:45], vcc
    s_nop 3
    s_cbranch_execz L_xab6_done
    buffer_load_ubyte v101, v100, s[8:11], s42 offen sc1
    s_waitcnt vmcnt(0)
    ds_add_u32 v101, v98 offset:1280
    s_mov_b64 exec, -1
    v_add_u32 v99, 8, v99
    v_add_u32 v100, 8, v100
    s_nop 1
    s_branch L_xab6
L_xab6_done:
    s_mov_b64 exec, -1
    s_mov_b32 s42, 10826752
    v_sub_u32 v102, v63, v97
    v_lshrrev_b32 v102, 4, v102
    v_add_u32 v102, v102, v97
    v_add_u32 v99, 20, v96
    v_add_u32 v100, 20, v102
L_xab7:
    v_cmp_lt_u32 vcc, v99, v47
    s_and_saveexec_b64 s[44:45], vcc
    s_nop 3
    s_cbranch_execz L_xab7_done
    buffer_load_ubyte v101, v100, s[8:11], s42 offen sc1
    s_waitcnt vmcnt(0)
    ds_add_u32 v101, v98 offset:1280
    s_mov_b64 exec, -1
    v_add_u32 v99, 8, v99
    v_add_u32 v100, 8, v100
    s_nop 1
    s_branch L_xab7
L_xab7_done:
    s_mov_b64 exec, -1
L2_bnoxa:
    s_mov_b64 exec, 1
    v_mov_b32 v101, 0
    s_waitcnt lgkmcnt(0)
    ds_add_u32 v101, v98 offset:864
    s_mov_b64 exec, -1
    v_mov_b32 v101, 0
    s_mov_b32 s44, 0
L_spbs:
    ds_read_b32 v99, v101 offset:864
    s_waitcnt lgkmcnt(0)
    v_readfirstlane_b32 s42, v99
    s_add_u32 s44, s44, 1
    s_cmp_ge_u32 s42, 4
    s_cbranch_scc1 L_spbs_ok
    s_cmp_lt_u32 s44, 0x400000
    s_cbranch_scc1 L_spbs
L_spbs_ok:
    ds_read_b32 v99, v124 offset:1024
    ds_read_b32 v100, v124 offset:1280
    s_waitcnt lgkmcnt(0)
    v_add_u32 v100, v99, v100
    v_mov_b32 v103, v100
    s_nop 1
    v_add_u32_dpp v103, v103, v103 row_shr:1 row_mask:0xf bank_mask:0xf
    s_nop 1
    v_add_u32_dpp v103, v103, v103 row_shr:2 row_mask:0xf bank_mask:0xf
    s_nop 1
    v_add_u32_dpp v103, v103, v103 row_shr:4 row_mask:0xf bank_mask:0xf
    s_nop 1
    v_add_u32_dpp v103, v103, v103 row_shr:8 row_mask:0xf bank_mask:0xf
    s_nop 1
    v_add_u32_dpp v103, v103, v103 row_bcast:15 row_mask:0xa bank_mask:0xf
    s_nop 1
    v_add_u32_dpp v103, v103, v103 row_bcast:31 row_mask:0xc bank_mask:0xf
    v_sub_u32 v103, v103, v100
    v_add_u32 v103, 1952, v103
    ds_bpermute_b32 v64, v64, v103
    ds_bpermute_b32 v65, v65, v103
    ds_bpermute_b32 v66, v66, v103
    ds_bpermute_b32 v67, v67, v103
    ds_bpermute_b32 v68, v68, v103
    ds_bpermute_b32 v69, v69, v103
    ds_bpermute_b32 v70, v70, v103
    ds_bpermute_b32 v71, v71, v103
    ds_bpermute_b32 v72, v72, v103
    ds_bpermute_b32 v73, v73, v103
    ds_bpermute_b32 v74, v74, v103
    ds_bpermute_b32 v75, v75, v103
    ds_bpermute_b32 v76, v76, v103
    ds_bpermute_b32 v77, v77, v103
    ds_bpermute_b32 v78, v78, v103
    ds_bpermute_b32 v79, v79, v103
    s_cmp_lg_u32 s21, 0
    s_cbranch_scc1 L2_bnoinfo
    v_lshl_or_b32 v100, v100, 16, v103
    s_mov_b32 exec_lo, 4261412864
    ds_write_b32 v124, v100 offset:1792
    s_mov_b64 exec, -1
L2_bnoinfo:
    s_waitcnt lgkmcnt(0)
    v_add_lshl_u32 v64, v64, v80, 4
    v_add_lshl_u32 v65, v65, v81, 4
    v_add_lshl_u32 v66, v66, v82, 4
    v_add_lshl_u32 v67, v67, v83, 4
    v_add_lshl_u32 v68, v68, v84, 4
    v_add_lshl_u32 v69, v69, v85, 4
    v_add_lshl_u32 v70, v70, v86, 4
    v_add_lshl_u32 v71, v71, v87, 4
    v_add_lshl_u32 v72, v72, v88, 4
    v_add_lshl_u32 v73, v73, v89, 4
    v_add_lshl_u32 v74, v74, v90, 4
    v_add_lshl_u32 v75, v75, v91, 4
    v_add_lshl_u32 v76, v76, v92, 4
    v_add_lshl_u32 v77, v77, v93, 4
    v_add_lshl_u32 v78, v78, v94, 4
    v_add_lshl_u32 v79, v79, v95, 4
    v_mov_b32 v98, v99
    s_mov_b32 s42, 1132544
    s_mov_b64 exec, -1
    v_cndmask_b32 v101, 2.0, v58, s[60:61]
    buffer_load_dwordx4 v[80:83], v101, s[8:11], s42 offen offset:0 sc1
    s_mov_b32 s42, 1132544
    s_mov_b64 exec, -1
    v_cndmask_b32 v102, 2.0, v58, s[62:63]
    buffer_load_dwordx4 v[84:87], v102, s[8:11], s42 offen offset:128 sc1
    s_mov_b32 s42, 1698816
    s_mov_b64 exec, -1
    v_cndmask_b32 v101, 2.0, v59, s[64:65]
    buffer_load_dwordx4 v[88:91], v101, s[8:11], s42 offen offset:0 sc1
    s_mov_b32 s42, 1698816
    s_mov_b64 exec, -1
    v_cndmask_b32 v102, 2.0, v59, s[66:67]
    buffer_load_dwordx4 v[92:95], v102, s[8:11], s42 offen offset:128 sc1
    s_waitcnt vmcnt(7)
    s_mov_b64 exec, s[52:53]
    ds_write_b128 v64, v[108:111] offset:2176
    s_mov_b32 s42, 9060352
    s_mov_b64 exec, -1
    v_cndmask_b32 v101, 2.0, v60, s[68:69]
    buffer_load_dwordx4 v[108:111], v101, s[8:11], s42 offen offset:0 sc1
    s_waitcnt vmcnt(7)
    s_mov_b64 exec, s[54:55]
    ds_write_b128 v65, v[112:115] offset:2176
    s_mov_b32 s42, 9060352
    s_mov_b64 exec, -1
    v_cndmask_b32 v102, 2.0, v60, s[70:71]
    buffer_load_dwordx4 v[112:115], v102, s[8:11], s42 offen offset:128 sc1
    s_waitcnt vmcnt(7)
    s_mov_b64 exec, s[56:57]
    ds_write_b128 v66, v[116:119] offset:2176
    s_mov_b32 s42, 9626624
    s_mov_b64 exec, -1
    v_cndmask_b32 v101, 2.0, v61, s[72:73]
    buffer_load_dwordx4 v[116:119], v101, s[8:11], s42 offen offset:0 sc1
    s_waitcnt vmcnt(7)
    s_mov_b64 exec, s[58:59]
    ds_write_b128 v67, v[120:123] offset:2176
    s_mov_b32 s42, 9626624
    s_mov_b64 exec, -1
    v_cndmask_b32 v102, 2.0, v61, s[74:75]
    buffer_load_dwordx4 v[120:123], v102, s[8:11], s42 offen offset:128 sc1
    s_waitcnt vmcnt(7)
    s_mov_b64 exec, s[60:61]
    ds_write_b128 v68, v[80:83] offset:2176
    s_mov_b32 s42, 10192896
    s_mov_b64 exec, -1
    v_cndmask_b32 v101, 2.0, v62, s[76:77]
    buffer_load_dwordx4 v[80:83], v101, s[8:11], s42 offen offset:0 sc1
    s_waitcnt vmcnt(7)
    s_mov_b64 exec, s[62:63]
    ds_write_b128 v69, v[84:87] offset:2176
    s_mov_b32 s42, 10192896
    s_mov_b64 exec, -1
    v_cndmask_b32 v102, 2.0, v62, s[78:79]
    buffer_load_dwordx4 v[84:87], v102, s[8:11], s42 offen offset:128 sc1
    s_waitcnt vmcnt(7)
    s_mov_b64 exec, s[64:65]
    ds_write_b128 v70, v[88:91] offset:2176
    s_mov_b32 s42, 10759168
    s_mov_b64 exec, -1
    v_cndmask_b32 v101, 2.0, v63, s[80:81]
    buffer_load_dwordx4 v[88:91], v101, s[8:11], s42 offen offset:0 sc1
    s_waitcnt vmcnt(7)
    s_mov_b64 exec, s[66:67]
    ds_write_b128 v71, v[92:95] offset:2176
    s_mov_b32 s42, 10759168
    s_mov_b64 exec, -1
    v_cndmask_b32 v102, 2.0, v63, s[82:83]
    buffer_load_dwordx4 v[92:95], v102, s[8:11], s42 offen offset:128 sc1
    s_waitcnt vmcnt(7)
    s_mov_b64 exec, s[68:69]
    ds_write_b128 v72, v[108:111] offset:2176
    s_waitcnt vmcnt(6)
    s_mov_b64 exec, s[70:71]
    ds_write_b128 v73, v[112:115] offset:2176
    s_waitcnt vmcnt(5)
    s_mov_b64 exec, s[72:73]
    ds_write_b128 v74, v[116:119] offset:2176
    s_waitcnt vmcnt(4)
    s_mov_b64 exec, s[74:75]
    ds_write_b128 v75, v[120:123] offset:2176
    s_waitcnt vmcnt(3)
    s_mov_b64 exec, s[76:77]
    ds_write_b128 v76, v[80:83] offset:2176
    s_waitcnt vmcnt(2)
    s_mov_b64 exec, s[78:79]
    ds_write_b128 v77, v[84:87] offset:2176
    s_waitcnt vmcnt(1)
    s_mov_b64 exec, s[80:81]
    ds_write_b128 v78, v[88:91] offset:2176
    s_waitcnt vmcnt(0)
    s_mov_b64 exec, s[82:83]
    ds_write_b128 v79, v[92:95] offset:2176
    s_mov_b64 exec, -1
    s_cmp_eq_u32 s35, 0
    s_cbranch_scc1 L2_bnoxb
    v_and_b32 v99, 0xff, v48
    ds_bpermute_b32 v99, v99, v103
    v_min_u32 v101, 20, v40
    v_add_u32 v102, 16, v96
    v_cmp_lt_u32 vcc, v102, v101
    s_and_saveexec_b64 s[44:45], vcc
    s_nop 3
    s_cbranch_execz L2_bw2b0
    s_mov_b32 s42, 0
    buffer_load_dwordx4 v[108:111], v56, s[8:11], s42 offen offset:256 sc1
    v_lshrrev_b32 v48, 8, v48
    s_waitcnt vmcnt(0) lgkmcnt(0)
    v_add_lshl_u32 v99, v99, v48, 4
    ds_write_b128 v99, v[108:111] offset:2176
L2_bw2b0:
    s_mov_b64 exec, -1
    s_waitcnt lgkmcnt(0)
    v_and_b32 v99, 0xff, v49
    ds_bpermute_b32 v99, v99, v103
    v_min_u32 v101, 20, v41
    v_add_u32 v102, 16, v96
    v_cmp_lt_u32 vcc, v102, v101
    s_and_saveexec_b64 s[44:45], vcc
    s_nop 3
    s_cbranch_execz L2_bw2b1
    s_mov_b32 s42, 566272
    buffer_load_dwordx4 v[108:111], v57, s[8:11], s42 offen offset:256 sc1
    v_lshrrev_b32 v49, 8, v49
    s_waitcnt vmcnt(0) lgkmcnt(0)
    v_add_lshl_u32 v99, v99, v49, 4
    ds_write_b128 v99, v[108:111] offset:2176
L2_bw2b1:
    s_mov_b64 exec, -1
    s_waitcnt lgkmcnt(0)
    v_and_b32 v99, 0xff, v50
    ds_bpermute_b32 v99, v99, v103
    v_min_u32 v101, 20, v42
    v_add_u32 v102, 16, v96
    v_cmp_lt_u32 vcc, v102, v101
    s_and_saveexec_b64 s[44:45], vcc
    s_nop 3
    s_cbranch_execz L2_bw2b2
    s_mov_b32 s42, 1132544
    buffer_load_dwordx4 v[108:111], v58, s[8:11], s42 offen offset:256 sc1
    v_lshrrev_b32 v50, 8, v50
    s_waitcnt vmcnt(0) lgkmcnt(0)
    v_add_lshl_u32 v99, v99, v50, 4
    ds_write_b128 v99, v[108:111] offset:2176
L2_bw2b2:
    s_mov_b64 exec, -1
    s_waitcnt lgkmcnt(0)
    v_and_b32 v99, 0xff, v51
    ds_bpermute_b32 v99, v99, v103
    v_min_u32 v101, 20, v43
    v_add_u32 v102, 16, v96
    v_cmp_lt_u32 vcc, v102, v101
    s_and_saveexec_b64 s[44:45], vcc
    s_nop 3
    s_cbranch_execz L2_bw2b3
    s_mov_b32 s42, 1698816
    buffer_load_dwordx4 v[108:111], v59, s[8:11], s42 offen offset:256 sc1
    v_lshrrev_b32 v51, 8, v51
    s_waitcnt vmcnt(0) lgkmcnt(0)
    v_add_lshl_u32 v99, v99, v51, 4
    ds_write_b128 v99, v[108:111] offset:2176
L2_bw2b3:
    s_mov_b64 exec, -1
    s_waitcnt lgkmcnt(0)
    v_and_b32 v99, 0xff, v52
    ds_bpermute_b32 v99, v99, v103
    v_min_u32 v101, 20, v44
    v_add_u32 v102, 16, v96
    v_cmp_lt_u32 vcc, v102, v101
    s_and_saveexec_b64 s[44:45], vcc
    s_nop 3
    s_cbranch_execz L2_bw2b4
    s_mov_b32 s42, 9060352
    buffer_load_dwordx4 v[108:111], v60, s[8:11], s42 offen offset:256 sc1
    v_lshrrev_b32 v52, 8, v52
    s_waitcnt vmcnt(0) lgkmcnt(0)
    v_add_lshl_u32 v99, v99, v52, 4
    ds_write_b128 v99, v[108:111] offset:2176
L2_bw2b4:
    s_mov_b64 exec, -1
    s_waitcnt lgkmcnt(0)
    v_and_b32 v99, 0xff, v53
    ds_bpermute_b32 v99, v99, v103
    v_min_u32 v101, 20, v45
    v_add_u32 v102, 16, v96
    v_cmp_lt_u32 vcc, v102, v101
    s_and_saveexec_b64 s[44:45], vcc
    s_nop 3
    s_cbranch_execz L2_bw2b5
    s_mov_b32 s42, 9626624
    buffer_load_dwordx4 v[108:111], v61, s[8:11], s42 offen offset:256 sc1
    v_lshrrev_b32 v53, 8, v53
    s_waitcnt vmcnt(0) lgkmcnt(0)
    v_add_lshl_u32 v99, v99, v53, 4
    ds_write_b128 v99, v[108:111] offset:2176
L2_bw2b5:
    s_mov_b64 exec, -1
    s_waitcnt lgkmcnt(0)
    v_and_b32 v99, 0xff, v54
    ds_bpermute_b32 v99, v99, v103
    v_min_u32 v101, 20, v46
    v_add_u32 v102, 16, v96
    v_cmp_lt_u32 vcc, v102, v101
    s_and_saveexec_b64 s[44:45], vcc
    s_nop 3
    s_cbranch_execz L2_bw2b6
    s_mov_b32 s42, 10192896
    buffer_load_dwordx4 v[108:111], v62, s[8:11], s42 offen offset:256 sc1
    v_lshrrev_b32 v54, 8, v54
    s_waitcnt vmcnt(0) lgkmcnt(0)
    v_add_lshl_u32 v99, v99, v54, 4
    ds_write_b128 v99, v[108:111] offset:2176
L2_bw2b6:
    s_mov_b64 exec, -1
    s_waitcnt lgkmcnt(0)
    v_and_b32 v99, 0xff, v55
    ds_bpermute_b32 v99, v99, v103
    v_min_u32 v101, 20, v47
    v_add_u32 v102, 16, v96
    v_cmp_lt_u32 vcc, v102, v101
    s_and_saveexec_b64 s[44:45], vcc
    s_nop 3
    s_cbranch_execz L2_bw2b7
    s_mov_b32 s42, 10759168
    buffer_load_dwordx4 v[108:111], v63, s[8:11], s42 offen offset:256 sc1
    v_lshrrev_b32 v55, 8, v55
    s_waitcnt vmcnt(0) lgkmcnt(0)
    v_add_lshl_u32 v99, v99, v55, 4
    ds_write_b128 v99, v[108:111] offset:2176
L2_bw2b7:
    s_mov_b64 exec, -1
    s_waitcnt lgkmcnt(0)
    v_add_u32 v103, v103, v98
    v_mov_b32 v98, 1
    s_mov_b32 s42, 67584
    s_mov_b32 s43, 0
    v_sub_u32 v48, v56, v97
    v_lshrrev_b32 v48, 4, v48
    v_add_u32 v48, v48, v97
    v_add_u32 v99, 20, v96
    v_add_u32 v100, 20, v48
    v_add_u32 v56, 320, v56
L_xbb0:
    v_cmp_lt_u32 vcc, v99, v40
    s_and_saveexec_b64 s[44:45], vcc
    s_nop 3
    s_cbranch_execz L_xbb0_done
    buffer_load_ubyte v101, v100, s[8:11], s42 offen sc1
    buffer_load_dwordx4 v[108:111], v56, s[8:11], s43 offen sc1
    s_waitcnt vmcnt(0)
    ds_add_rtn_u32 v102, v101, v98 offset:1536
    s_mov_b64 exec, -1
    ds_bpermute_b32 v101, v101, v103
    s_waitcnt lgkmcnt(0)
    v_add_lshl_u32 v101, v101, v102, 4
    s_mov_b64 exec, vcc
    ds_write_b128 v101, v[108:111] offset:2176
    s_mov_b64 exec, -1
    v_add_u32 v99, 8, v99
    v_add_u32 v100, 8, v100
    v_add_u32 v56, 128, v56
    s_nop 1
    s_branch L_xbb0
L_xbb0_done:
    s_mov_b64 exec, -1
    s_mov_b32 s42, 633856
    s_mov_b32 s43, 566272
    v_sub_u32 v49, v57, v97
    v_lshrrev_b32 v49, 4, v49
    v_add_u32 v49, v49, v97
    v_add_u32 v99, 20, v96
    v_add_u32 v100, 20, v49
    v_add_u32 v57, 320, v57
L_xbb1:
    v_cmp_lt_u32 vcc, v99, v41
    s_and_saveexec_b64 s[44:45], vcc
    s_nop 3
    s_cbranch_execz L_xbb1_done
    buffer_load_ubyte v101, v100, s[8:11], s42 offen sc1
    buffer_load_dwordx4 v[108:111], v57, s[8:11], s43 offen sc1
    s_waitcnt vmcnt(0)
    ds_add_rtn_u32 v102, v101, v98 offset:1536
    s_mov_b64 exec, -1
    ds_bpermute_b32 v101, v101, v103
    s_waitcnt lgkmcnt(0)
    v_add_lshl_u32 v101, v101, v102, 4
    s_mov_b64 exec, vcc
    ds_write_b128 v101, v[108:111] offset:2176
    s_mov_b64 exec, -1
    v_add_u32 v99, 8, v99
    v_add_u32 v100, 8, v100
    v_add_u32 v57, 128, v57
    s_nop 1
    s_branch L_xbb1
L_xbb1_done:
    s_mov_b64 exec, -1
    s_mov_b32 s42, 1200128
    s_mov_b32 s43, 1132544
    v_sub_u32 v50, v58, v97
    v_lshrrev_b32 v50, 4, v50
    v_add_u32 v50, v50, v97
    v_add_u32 v99, 20, v96
    v_add_u32 v100, 20, v50
    v_add_u32 v58, 320, v58
L_xbb2:
    v_cmp_lt_u32 vcc, v99, v42
    s_and_saveexec_b64 s[44:45], vcc
    s_nop 3
    s_cbranch_execz L_xbb2_done
    buffer_load_ubyte v101, v100, s[8:11], s42 offen sc1
    buffer_load_dwordx4 v[108:111], v58, s[8:11], s43 offen sc1
    s_waitcnt vmcnt(0)
    ds_add_rtn_u32 v102, v101, v98 offset:1536
    s_mov_b64 exec, -1
    ds_bpermute_b32 v101, v101, v103
    s_waitcnt lgkmcnt(0)
    v_add_lshl_u32 v101, v101, v102, 4
    s_mov_b64 exec, vcc
    ds_write_b128 v101, v[108:111] offset:2176
    s_mov_b64 exec, -1
    v_add_u32 v99, 8, v99
    v_add_u32 v100, 8, v100
    v_add_u32 v58, 128, v58
    s_nop 1
    s_branch L_xbb2
L_xbb2_done:
    s_mov_b64 exec, -1
    s_mov_b32 s42, 1766400
    s_mov_b32 s43, 1698816
    v_sub_u32 v51, v59, v97
    v_lshrrev_b32 v51, 4, v51
    v_add_u32 v51, v51, v97
    v_add_u32 v99, 20, v96
    v_add_u32 v100, 20, v51
    v_add_u32 v59, 320, v59
L_xbb3:
    v_cmp_lt_u32 vcc, v99, v43
    s_and_saveexec_b64 s[44:45], vcc
    s_nop 3
    s_cbranch_execz L_xbb3_done
    buffer_load_ubyte v101, v100, s[8:11], s42 offen sc1
    buffer_load_dwordx4 v[108:111], v59, s[8:11], s43 offen sc1
    s_waitcnt vmcnt(0)
    ds_add_rtn_u32 v102, v101, v98 offset:1536
    s_mov_b64 exec, -1
    ds_bpermute_b32 v101, v101, v103
    s_waitcnt lgkmcnt(0)
    v_add_lshl_u32 v101, v101, v102, 4
    s_mov_b64 exec, vcc
    ds_write_b128 v101, v[108:111] offset:2176
    s_mov_b64 exec, -1
    v_add_u32 v99, 8, v99
    v_add_u32 v100, 8, v100
    v_add_u32 v59, 128, v59
    s_nop 1
    s_branch L_xbb3
L_xbb3_done:
    s_mov_b64 exec, -1
    s_mov_b32 s42, 9127936
    s_mov_b32 s43, 9060352
    v_sub_u32 v52, v60, v97
    v_lshrrev_b32 v52, 4, v52
    v_add_u32 v52, v52, v97
    v_add_u32 v99, 20, v96
    v_add_u32 v100, 20, v52
    v_add_u32 v60, 320, v60
L_xbb4:
    v_cmp_lt_u32 vcc, v99, v44
    s_and_saveexec_b64 s[44:45], vcc
    s_nop 3
    s_cbranch_execz L_xbb4_done
    buffer_load_ubyte v101, v100, s[8:11], s42 offen sc1
    buffer_load_dwordx4 v[108:111], v60, s[8:11], s43 offen sc1
    s_waitcnt vmcnt(0)
    ds_add_rtn_u32 v102, v101, v98 offset:1536
    s_mov_b64 exec, -1
    ds_bpermute_b32 v101, v101, v103
    s_waitcnt lgkmcnt(0)
    v_add_lshl_u32 v101, v101, v102, 4
    s_mov_b64 exec, vcc
    ds_write_b128 v101, v[108:111] offset:2176
    s_mov_b64 exec, -1
    v_add_u32 v99, 8, v99
    v_add_u32 v100, 8, v100
    v_add_u32 v60, 128, v60
    s_nop 1
    s_branch L_xbb4
L_xbb4_done:
    s_mov_b64 exec, -1
    s_mov_b32 s42, 9694208
    s_mov_b32 s43, 9626624
    v_sub_u32 v53, v61, v97
    v_lshrrev_b32 v53, 4, v53
    v_add_u32 v53, v53, v97
    v_add_u32 v99, 20, v96
    v_add_u32 v100, 20, v53
    v_add_u32 v61, 320, v61
L_xbb5:
    v_cmp_lt_u32 vcc, v99, v45
    s_and_saveexec_b64 s[44:45], vcc
    s_nop 3
    s_cbranch_execz L_xbb5_done
    buffer_load_ubyte v101, v100, s[8:11], s42 offen sc1
    buffer_load_dwordx4 v[108:111], v61, s[8:11], s43 offen sc1
    s_waitcnt vmcnt(0)
    ds_add_rtn_u32 v102, v101, v98 offset:1536
    s_mov_b64 exec, -1
    ds_bpermute_b32 v101, v101, v103
    s_waitcnt lgkmcnt(0)
    v_add_lshl_u32 v101, v101, v102, 4
    s_mov_b64 exec, vcc
    ds_write_b128 v101, v[108:111] offset:2176
    s_mov_b64 exec, -1
    v_add_u32 v99, 8, v99
    v_add_u32 v100, 8, v100
    v_add_u32 v61, 128, v61
    s_nop 1
    s_branch L_xbb5
L_xbb5_done:
    s_mov_b64 exec, -1
    s_mov_b32 s42, 10260480
    s_mov_b32 s43, 10192896
    v_sub_u32 v54, v62, v97
    v_lshrrev_b32 v54, 4, v54
    v_add_u32 v54, v54, v97
    v_add_u32 v99, 20, v96
    v_add_u32 v100, 20, v54
    v_add_u32 v62, 320, v62
L_xbb6:
    v_cmp_lt_u32 vcc, v99, v46
    s_and_saveexec_b64 s[44:45], vcc
    s_nop 3
    s_cbranch_execz L_xbb6_done
    buffer_load_ubyte v101, v100, s[8:11], s42 offen sc1
    buffer_load_dwordx4 v[108:111], v62, s[8:11], s43 offen sc1
    s_waitcnt vmcnt(0)
    ds_add_rtn_u32 v102, v101, v98 offset:1536
    s_mov_b64 exec, -1
    ds_bpermute_b32 v101, v101, v103
    s_waitcnt lgkmcnt(0)
    v_add_lshl_u32 v101, v101, v102, 4
    s_mov_b64 exec, vcc
    ds_write_b128 v101, v[108:111] offset:2176
    s_mov_b64 exec, -1
    v_add_u32 v99, 8, v99
    v_add_u32 v100, 8, v100
    v_add_u32 v62, 128, v62
    s_nop 1
    s_branch L_xbb6
L_xbb6_done:
    s_mov_b64 exec, -1
    s_mov_b32 s42, 10826752
    s_mov_b32 s43, 10759168
    v_sub_u32 v55, v63, v97
    v_lshrrev_b32 v55, 4, v55
    v_add_u32 v55, v55, v97
    v_add_u32 v99, 20, v96
    v_add_u32 v100, 20, v55
    v_add_u32 v63, 320, v63
L_xbb7:
    v_cmp_lt_u32 vcc, v99, v47
    s_and_saveexec_b64 s[44:45], vcc
    s_nop 3
    s_cbranch_execz L_xbb7_done
    buffer_load_ubyte v101, v100, s[8:11], s42 offen sc1
    buffer_load_dwordx4 v[108:111], v63, s[8:11], s43 offen sc1
    s_waitcnt vmcnt(0)
    ds_add_rtn_u32 v102, v101, v98 offset:1536
    s_mov_b64 exec, -1
    ds_bpermute_b32 v101, v101, v103
    s_waitcnt lgkmcnt(0)
    v_add_lshl_u32 v101, v101, v102, 4
    s_mov_b64 exec, vcc
    ds_write_b128 v101, v[108:111] offset:2176
    s_mov_b64 exec, -1
    v_add_u32 v99, 8, v99
    v_add_u32 v100, 8, v100
    v_add_u32 v63, 128, v63
    s_nop 1
    s_branch L_xbb7
L_xbb7_done:
    s_mov_b64 exec, -1
L2_bnoxb:
    s_waitcnt lgkmcnt(0)
    v_mov_b32 v40, 0
    v_mov_b32 v41, 0
    v_mov_b32 v42, 0
    v_mov_b32 v43, 0
    v_mov_b32 v44, 0
    v_mov_b32 v45, 0
    v_mov_b32 v46, 0
    v_mov_b32 v47, 0
    v_mov_b32 v48, 0
    v_mov_b32 v49, 0
    v_mov_b32 v50, 0
    v_mov_b32 v51, 0
    v_mov_b32 v52, 0
    v_mov_b32 v53, 0
    v_mov_b32 v54, 0
    v_mov_b32 v55, 0
    v_mov_b32 v56, 0
    v_mov_b32 v57, 0
    v_mov_b32 v58, 0
    v_mov_b32 v59, 0
    v_mov_b32 v60, 0
    v_mov_b32 v61, 0
    v_mov_b32 v62, 0
    v_mov_b32 v63, 0
    v_mov_b32 v64, 0
    v_mov_b32 v65, 0
    v_mov_b32 v66, 0
    v_mov_b32 v67, 0
    v_mov_b32 v68, 0
    v_mov_b32 v69, 0
    v_mov_b32 v70, 0
    v_mov_b32 v71, 0
    v_mov_b32 v72, 0
    v_mov_b32 v73, 0
    v_mov_b32 v74, 0
    v_mov_b32 v75, 0
    v_mov_b32 v76, 0
    v_mov_b32 v77, 0
    v_mov_b32 v78, 0
    v_mov_b32 v79, 0
    v_mov_b32 v80, 0
    v_mov_b32 v81, 0
    v_mov_b32 v82, 0
    v_mov_b32 v83, 0
    v_mov_b32 v84, 0
    v_mov_b32 v85, 0
    v_mov_b32 v86, 0
    v_mov_b32 v87, 0
    v_mov_b32 v88, 0
    v_mov_b32 v89, 0
    v_mov_b32 v90, 0
    v_mov_b32 v91, 0
    v_mov_b32 v92, 0
    v_mov_b32 v93, 0
    v_mov_b32 v94, 0
    v_mov_b32 v95, 0
    v_mov_b32 v96, 0
    v_mov_b32 v97, 0
    v_mov_b32 v98, 0
    v_mov_b32 v99, 0
    v_mov_b32 v100, 0
    v_mov_b32 v101, 0
    v_mov_b32 v102, 0
    v_mov_b32 v103, 0
    s_cmp_lg_u32 s21, 1
    s_cbranch_scc1 L2_bnoguard
    s_add_u32 s42, s34, 1952
    s_lshl_b32 s42, s42, 4
    v_lshl_add_u32 v108, v124, 2, s42
    ds_write_b128 v108, v[40:43] offset:2176
    s_waitcnt lgkmcnt(0)
L2_bnoguard:
    v_mov_b32 v108, 1
    s_mov_b64 exec, 1
    ds_add_u32 v40, v108 offset:868
    s_mov_b64 exec, -1
    s_branch L2_m_tiles
L2_m_slowC:
    s_barrier
L2_m_tiles:
    v_mov_b32 v108, 0
    s_mov_b32 s43, 0
L_spt00:
    ds_read_b32 v109, v108 offset:784
    s_waitcnt lgkmcnt(0)
    v_readfirstlane_b32 s42, v109
    s_add_u32 s43, s43, 1
    s_cmp_ge_u32 s42, 16
    s_cbranch_scc1 L_spt00_ok
    s_sleep 12
    s_cmp_lt_u32 s43, 0x400000
    s_cbranch_scc1 L_spt00
L_spt00_ok:
    ds_read_b128 v[108:111], v104 offset:0
    ds_read_b128 v[112:115], v105 offset:0
    ds_read_b128 v[116:119], v106 offset:0
    ds_read_b128 v[120:123], v107 offset:0
    s_waitcnt lgkmcnt(3)
    v_mfma_f32_16x16x32_bf16 v[40:43], v[0:3], v[108:111], v[40:43]
    ds_read_b128 v[108:111], v104 offset:256
    s_waitcnt lgkmcnt(3)
    v_mfma_f32_16x16x32_bf16 v[40:43], v[4:7], v[112:115], v[40:43]
    ds_read_b128 v[112:115], v105 offset:256
    s_waitcnt lgkmcnt(3)
    v_mfma_f32_16x16x32_bf16 v[44:47], v[24:27], v[116:119], v[44:47]
    ds_read_b128 v[116:119], v106 offset:256
    s_waitcnt lgkmcnt(3)
    v_mfma_f32_16x16x32_bf16 v[44:47], v[28:31], v[120:123], v[44:47]
    ds_read_b128 v[120:123], v107 offset:256
    s_waitcnt lgkmcnt(3)
    v_mfma_f32_16x16x32_bf16 v[44:47], v[16:19], v[108:111], v[44:47]
    ds_read_b128 v[108:111], v104 offset:512
    s_waitcnt lgkmcnt(3)
    v_mfma_f32_16x16x32_bf16 v[44:47], v[20:23], v[112:115], v[44:47]
    ds_read_b128 v[112:115], v105 offset:512
    s_waitcnt lgkmcnt(3)
    v_mfma_f32_16x16x32_bf16 v[40:43], v[8:11], v[116:119], v[40:43]
    ds_read_b128 v[116:119], v106 offset:512
    s_waitcnt lgkmcnt(3)
    v_mfma_f32_16x16x32_bf16 v[40:43], v[12:15], v[120:123], v[40:43]
    ds_read_b128 v[120:123], v107 offset:512
    s_waitcnt lgkmcnt(3)
    v_mfma_f32_16x16x32_bf16 v[48:51], v[16:19], v[108:111], v[48:51]
    ds_read_b128 v[108:111], v104 offset:768
    s_waitcnt lgkmcnt(3)
    v_mfma_f32_16x16x32_bf16 v[48:51], v[20:23], v[112:115], v[48:51]
    ds_read_b128 v[112:115], v105 offset:768
    s_waitcnt lgkmcnt(3)
    v_mfma_f32_16x16x32_bf16 v[52:55], v[32:35], v[116:119], v[52:55]
    ds_read_b128 v[116:119], v106 offset:768
    s_waitcnt lgkmcnt(3)
    v_mfma_f32_16x16x32_bf16 v[52:55], v[36:39], v[120:123], v[52:55]
    ds_read_b128 v[120:123], v107 offset:768
    s_waitcnt lgkmcnt(3)
    v_mfma_f32_16x16x32_bf16 v[52:55], v[16:19], v[108:111], v[52:55]
    s_waitcnt lgkmcnt(2)
    v_mfma_f32_16x16x32_bf16 v[52:55], v[20:23], v[112:115], v[52:55]
    s_waitcnt lgkmcnt(1)
    v_mfma_f32_16x16x32_bf16 v[48:51], v[32:35], v[116:119], v[48:51]
    s_waitcnt lgkmcnt(0)
    v_mfma_f32_16x16x32_bf16 v[48:51], v[36:39], v[120:123], v[48:51]
    v_mov_b32 v108, 0
    v_mov_b32 v109, 1
    s_mov_b64 exec, 1
    ds_add_u32 v108, v109 offset:832
    s_mov_b64 exec, -1
    v_mov_b32 v108, 0
    s_mov_b32 s43, 0
L_spt01:
    ds_read_b32 v109, v108 offset:788
    s_waitcnt lgkmcnt(0)
    v_readfirstlane_b32 s42, v109
    s_add_u32 s43, s43, 1
    s_cmp_ge_u32 s42, 16
    s_cbranch_scc1 L_spt01_ok
    s_sleep 12
    s_cmp_lt_u32 s43, 0x400000
    s_cbranch_scc1 L_spt01
L_spt01_ok:
    ds_read_b128 v[108:111], v104 offset:16384
    ds_read_b128 v[112:115], v105 offset:16384
    ds_read_b128 v[116:119], v106 offset:16384
    ds_read_b128 v[120:123], v107 offset:16384
    s_waitcnt lgkmcnt(3)
    v_mfma_f32_16x16x32_bf16 v[56:59], v[0:3], v[108:111], v[56:59]
    ds_read_b128 v[108:111], v104 offset:16640
    s_waitcnt lgkmcnt(3)
    v_mfma_f32_16x16x32_bf16 v[56:59], v[4:7], v[112:115], v[56:59]
    ds_read_b128 v[112:115], v105 offset:16640
    s_waitcnt lgkmcnt(3)
    v_mfma_f32_16x16x32_bf16 v[60:63], v[24:27], v[116:119], v[60:63]
    ds_read_b128 v[116:119], v106 offset:16640
    s_waitcnt lgkmcnt(3)
    v_mfma_f32_16x16x32_bf16 v[60:63], v[28:31], v[120:123], v[60:63]
    ds_read_b128 v[120:123], v107 offset:16640
    s_waitcnt lgkmcnt(3)
    v_mfma_f32_16x16x32_bf16 v[60:63], v[16:19], v[108:111], v[60:63]
    ds_read_b128 v[108:111], v104 offset:16896
    s_waitcnt lgkmcnt(3)
    v_mfma_f32_16x16x32_bf16 v[60:63], v[20:23], v[112:115], v[60:63]
    ds_read_b128 v[112:115], v105 offset:16896
    s_waitcnt lgkmcnt(3)
    v_mfma_f32_16x16x32_bf16 v[56:59], v[8:11], v[116:119], v[56:59]
    ds_read_b128 v[116:119], v106 offset:16896
    s_waitcnt lgkmcnt(3)
    v_mfma_f32_16x16x32_bf16 v[56:59], v[12:15], v[120:123], v[56:59]
    ds_read_b128 v[120:123], v107 offset:16896
    s_waitcnt lgkmcnt(3)
    v_mfma_f32_16x16x32_bf16 v[64:67], v[16:19], v[108:111], v[64:67]
    ds_read_b128 v[108:111], v104 offset:17152
    s_waitcnt lgkmcnt(3)
    v_mfma_f32_16x16x32_bf16 v[64:67], v[20:23], v[112:115], v[64:67]
    ds_read_b128 v[112:115], v105 offset:17152
    s_waitcnt lgkmcnt(3)
    v_mfma_f32_16x16x32_bf16 v[68:71], v[32:35], v[116:119], v[68:71]
    ds_read_b128 v[116:119], v106 offset:17152
    s_waitcnt lgkmcnt(3)
    v_mfma_f32_16x16x32_bf16 v[68:71], v[36:39], v[120:123], v[68:71]
    ds_read_b128 v[120:123], v107 offset:17152
    s_waitcnt lgkmcnt(3)
    v_mfma_f32_16x16x32_bf16 v[68:71], v[16:19], v[108:111], v[68:71]
    s_waitcnt lgkmcnt(2)
    v_mfma_f32_16x16x32_bf16 v[68:71], v[20:23], v[112:115], v[68:71]
    s_waitcnt lgkmcnt(1)
    v_mfma_f32_16x16x32_bf16 v[64:67], v[32:35], v[116:119], v[64:67]
    s_waitcnt lgkmcnt(0)
    v_mfma_f32_16x16x32_bf16 v[64:67], v[36:39], v[120:123], v[64:67]
    v_mov_b32 v108, 0
    v_mov_b32 v109, 1
    s_mov_b64 exec, 1
    ds_add_u32 v108, v109 offset:836
    s_mov_b64 exec, -1
    v_mov_b32 v108, 0
    s_mov_b32 s43, 0
L_spt02:
    ds_read_b32 v109, v108 offset:792
    s_waitcnt lgkmcnt(0)
    v_readfirstlane_b32 s42, v109
    s_add_u32 s43, s43, 1
    s_cmp_ge_u32 s42, 16
    s_cbranch_scc1 L_spt02_ok
    s_sleep 12
    s_cmp_lt_u32 s43, 0x400000
    s_cbranch_scc1 L_spt02
L_spt02_ok:
    ds_read_b128 v[108:111], v104 offset:32768
    ds_read_b128 v[112:115], v105 offset:32768
    ds_read_b128 v[116:119], v106 offset:32768
    ds_read_b128 v[120:123], v107 offset:32768
    s_waitcnt lgkmcnt(3)
    v_mfma_f32_16x16x32_bf16 v[72:75], v[0:3], v[108:111], v[72:75]
    ds_read_b128 v[108:111], v104 offset:33024
    s_waitcnt lgkmcnt(3)
    v_mfma_f32_16x16x32_bf16 v[72:75], v[4:7], v[112:115], v[72:75]
    ds_read_b128 v[112:115], v105 offset:33024
    s_waitcnt lgkmcnt(3)
    v_mfma_f32_16x16x32_bf16 v[76:79], v[24:27], v[116:119], v[76:79]
    ds_read_b128 v[116:119], v106 offset:33024
    s_waitcnt lgkmcnt(3)
    v_mfma_f32_16x16x32_bf16 v[76:79], v[28:31], v[120:123], v[76:79]
    ds_read_b128 v[120:123], v107 offset:33024
    s_waitcnt lgkmcnt(3)
    v_mfma_f32_16x16x32_bf16 v[76:79], v[16:19], v[108:111], v[76:79]
    ds_read_b128 v[108:111], v104 offset:33280
    s_waitcnt lgkmcnt(3)
    v_mfma_f32_16x16x32_bf16 v[76:79], v[20:23], v[112:115], v[76:79]
    ds_read_b128 v[112:115], v105 offset:33280
    s_waitcnt lgkmcnt(3)
    v_mfma_f32_16x16x32_bf16 v[72:75], v[8:11], v[116:119], v[72:75]
    ds_read_b128 v[116:119], v106 offset:33280
    s_waitcnt lgkmcnt(3)
    v_mfma_f32_16x16x32_bf16 v[72:75], v[12:15], v[120:123], v[72:75]
    ds_read_b128 v[120:123], v107 offset:33280
    s_waitcnt lgkmcnt(3)
    v_mfma_f32_16x16x32_bf16 v[80:83], v[16:19], v[108:111], v[80:83]
    ds_read_b128 v[108:111], v104 offset:33536
    s_waitcnt lgkmcnt(3)
    v_mfma_f32_16x16x32_bf16 v[80:83], v[20:23], v[112:115], v[80:83]
    ds_read_b128 v[112:115], v105 offset:33536
    s_waitcnt lgkmcnt(3)
    v_mfma_f32_16x16x32_bf16 v[84:87], v[32:35], v[116:119], v[84:87]
    ds_read_b128 v[116:119], v106 offset:33536
    s_waitcnt lgkmcnt(3)
    v_mfma_f32_16x16x32_bf16 v[84:87], v[36:39], v[120:123], v[84:87]
    ds_read_b128 v[120:123], v107 offset:33536
    s_waitcnt lgkmcnt(3)
    v_mfma_f32_16x16x32_bf16 v[84:87], v[16:19], v[108:111], v[84:87]
    s_waitcnt lgkmcnt(2)
    v_mfma_f32_16x16x32_bf16 v[84:87], v[20:23], v[112:115], v[84:87]
    s_waitcnt lgkmcnt(1)
    v_mfma_f32_16x16x32_bf16 v[80:83], v[32:35], v[116:119], v[80:83]
    s_waitcnt lgkmcnt(0)
    v_mfma_f32_16x16x32_bf16 v[80:83], v[36:39], v[120:123], v[80:83]
    v_mov_b32 v108, 0
    v_mov_b32 v109, 1
    s_mov_b64 exec, 1
    ds_add_u32 v108, v109 offset:840
    s_mov_b64 exec, -1
    v_mov_b32 v108, 0
    s_mov_b32 s43, 0
L_spt03:
    ds_read_b32 v109, v108 offset:796
    s_waitcnt lgkmcnt(0)
    v_readfirstlane_b32 s42, v109
    s_add_u32 s43, s43, 1
    s_cmp_ge_u32 s42, 2
    s_cbranch_scc1 L_spt03_ok
    s_sleep 12
    s_cmp_lt_u32 s43, 0x400000
    s_cbranch_scc1 L_spt03
L_spt03_ok:
    ds_read_b128 v[108:111], v104 offset:49152
    ds_read_b128 v[112:115], v105 offset:49152
    ds_read_b128 v[116:119], v106 offset:49152
    ds_read_b128 v[120:123], v107 offset:49152
    s_waitcnt lgkmcnt(3)
    v_mfma_f32_16x16x32_bf16 v[88:91], v[0:3], v[108:111], v[88:91]
    ds_read_b128 v[108:111], v104 offset:49408
    s_waitcnt lgkmcnt(3)
    v_mfma_f32_16x16x32_bf16 v[88:91], v[4:7], v[112:115], v[88:91]
    ds_read_b128 v[112:115], v105 offset:49408
    s_waitcnt lgkmcnt(3)
    v_mfma_f32_16x16x32_bf16 v[92:95], v[24:27], v[116:119], v[92:95]
    ds_read_b128 v[116:119], v106 offset:49408
    s_waitcnt lgkmcnt(3)
    v_mfma_f32_16x16x32_bf16 v[92:95], v[28:31], v[120:123], v[92:95]
    ds_read_b128 v[120:123], v107 offset:49408
    s_waitcnt lgkmcnt(3)
    v_mfma_f32_16x16x32_bf16 v[92:95], v[16:19], v[108:111], v[92:95]
    ds_read_b128 v[108:111], v104 offset:49664
    s_waitcnt lgkmcnt(3)
    v_mfma_f32_16x16x32_bf16 v[92:95], v[20:23], v[112:115], v[92:95]
    ds_read_b128 v[112:115], v105 offset:49664
    s_waitcnt lgkmcnt(3)
    v_mfma_f32_16x16x32_bf16 v[88:91], v[8:11], v[116:119], v[88:91]
    ds_read_b128 v[116:119], v106 offset:49664
    s_waitcnt lgkmcnt(3)
    v_mfma_f32_16x16x32_bf16 v[88:91], v[12:15], v[120:123], v[88:91]
    ds_read_b128 v[120:123], v107 offset:49664
    s_waitcnt lgkmcnt(3)
    v_mfma_f32_16x16x32_bf16 v[96:99], v[16:19], v[108:111], v[96:99]
    ds_read_b128 v[108:111], v104 offset:49920
    s_waitcnt lgkmcnt(3)
    v_mfma_f32_16x16x32_bf16 v[96:99], v[20:23], v[112:115], v[96:99]
    ds_read_b128 v[112:115], v105 offset:49920
    s_waitcnt lgkmcnt(3)
    v_mfma_f32_16x16x32_bf16 v[100:103], v[32:35], v[116:119], v[100:103]
    ds_read_b128 v[116:119], v106 offset:49920
    s_waitcnt lgkmcnt(3)
    v_mfma_f32_16x16x32_bf16 v[100:103], v[36:39], v[120:123], v[100:103]
    ds_read_b128 v[120:123], v107 offset:49920
    s_waitcnt lgkmcnt(3)
    v_mfma_f32_16x16x32_bf16 v[100:103], v[16:19], v[108:111], v[100:103]
    s_waitcnt lgkmcnt(2)
    v_mfma_f32_16x16x32_bf16 v[100:103], v[20:23], v[112:115], v[100:103]
    s_waitcnt lgkmcnt(1)
    v_mfma_f32_16x16x32_bf16 v[96:99], v[32:35], v[116:119], v[96:99]
    s_waitcnt lgkmcnt(0)
    v_mfma_f32_16x16x32_bf16 v[96:99], v[36:39], v[120:123], v[96:99]
    v_mov_b32 v108, 0
    v_mov_b32 v109, 1
    s_mov_b64 exec, 1
    ds_add_u32 v108, v109 offset:844
    s_mov_b64 exec, -1
    s_cmp_eq_u32 s24, 0
    s_cbranch_scc1 L2_nopre0
    v_bfe_u32 v7, v124, 2, 4
    v_lshrrev_b32 v4, 7, v124
    s_lshl_b32 s42, s21, 1
    v_add_u32 v0, s42, v4
    v_xor_b32 v0, v0, v7
    v_and_b32 v0, 7, v0
    v_lshlrev_b32 v0, 4, v0
    v_lshl_add_u32 v0, v7, 9, v0
    v_bfe_u32 v7, v124, 6, 1
    v_lshl_add_u32 v0, v7, 3, v0
    v_add_u32 v0, 115968, v0
    s_lshl_b32 s42, s21, 2
    v_add_u32 v4, s42, v4
    v_bfe_u32 v3, v124, 2, 5
    v_and_b32 v7, 7, v4
    v_xor_b32 v1, v3, v7
    v_lshlrev_b32 v1, 4, v1
    v_lshl_add_u32 v1, v4, 9, v1
    v_add_u32 v1, 115968, v1
    v_xor_b32 v2, 32, v1
    v_lshlrev_b32 v3, 4, v3
    v_lshl_add_u32 v3, v4, 9, v3
    v_add_u32 v3, s40, v3
    v_mov_b32 v5, 0
    v_mov_b32 v6, 1
L2_nopre0:
    v_mov_b32 v108, 0
    s_mov_b32 s43, 0
L_spt10:
    ds_read_b32 v109, v108 offset:800
    s_waitcnt lgkmcnt(0)
    v_readfirstlane_b32 s42, v109
    s_add_u32 s43, s43, 1
    s_cmp_ge_u32 s42, 16
    s_cbranch_scc1 L_spt10_ok
    s_sleep 12
    s_cmp_lt_u32 s43, 0x400000
    s_cbranch_scc1 L_spt10
L_spt10_ok:
    ds_read_b128 v[108:111], v104 offset:0
    ds_read_b128 v[112:115], v105 offset:0
    ds_read_b128 v[116:119], v106 offset:0
    ds_read_b128 v[120:123], v107 offset:0
    s_waitcnt lgkmcnt(3)
    v_mfma_f32_16x16x32_bf16 v[48:51], v[24:27], v[108:111], v[48:51]
    ds_read_b128 v[108:111], v104 offset:256
    s_waitcnt lgkmcnt(3)
    v_mfma_f32_16x16x32_bf16 v[48:51], v[28:31], v[112:115], v[48:51]
    ds_read_b128 v[112:115], v105 offset:256
    s_waitcnt lgkmcnt(3)
    v_mfma_f32_16x16x32_bf16 v[52:55], v[24:27], v[116:119], v[52:55]
    ds_read_b128 v[116:119], v106 offset:256
    s_waitcnt lgkmcnt(3)
    v_mfma_f32_16x16x32_bf16 v[52:55], v[28:31], v[120:123], v[52:55]
    ds_read_b128 v[120:123], v107 offset:256
    s_waitcnt lgkmcnt(3)
    v_mfma_f32_16x16x32_bf16 v[52:55], v[32:35], v[108:111], v[52:55]
    ds_read_b128 v[108:111], v104 offset:512
    s_waitcnt lgkmcnt(3)
    v_mfma_f32_16x16x32_bf16 v[52:55], v[36:39], v[112:115], v[52:55]
    ds_read_b128 v[112:115], v105 offset:512
    s_waitcnt lgkmcnt(3)
    v_mfma_f32_16x16x32_bf16 v[48:51], v[32:35], v[116:119], v[48:51]
    ds_read_b128 v[116:119], v106 offset:512
    s_waitcnt lgkmcnt(3)
    v_mfma_f32_16x16x32_bf16 v[48:51], v[36:39], v[120:123], v[48:51]
    ds_read_b128 v[120:123], v107 offset:512
    s_waitcnt lgkmcnt(3)
    v_mfma_f32_16x16x32_bf16 v[40:43], v[8:11], v[108:111], v[40:43]
    ds_read_b128 v[108:111], v104 offset:768
    s_waitcnt lgkmcnt(3)
    v_mfma_f32_16x16x32_bf16 v[40:43], v[12:15], v[112:115], v[40:43]
    ds_read_b128 v[112:115], v105 offset:768
    s_waitcnt lgkmcnt(3)
    v_mfma_f32_16x16x32_bf16 v[44:47], v[32:35], v[116:119], v[44:47]
    ds_read_b128 v[116:119], v106 offset:768
    s_waitcnt lgkmcnt(3)
    v_mfma_f32_16x16x32_bf16 v[44:47], v[36:39], v[120:123], v[44:47]
    ds_read_b128 v[120:123], v107 offset:768
    s_waitcnt lgkmcnt(3)
    v_mfma_f32_16x16x32_bf16 v[44:47], v[32:35], v[108:111], v[44:47]
    s_waitcnt lgkmcnt(2)
    v_mfma_f32_16x16x32_bf16 v[44:47], v[36:39], v[112:115], v[44:47]
    s_waitcnt lgkmcnt(1)
    v_mfma_f32_16x16x32_bf16 v[40:43], v[8:11], v[116:119], v[40:43]
    s_waitcnt lgkmcnt(0)
    v_mfma_f32_16x16x32_bf16 v[40:43], v[12:15], v[120:123], v[40:43]
    s_cmp_eq_u32 s24, 0
    s_nop 6
    s_cbranch_scc1 L2_nofin0
    s_mov_b32 s42, 0xbfb8aa3b
    v_mul_f32 v108, s42, v40
    v_mul_f32 v109, s42, v41
    v_mul_f32 v110, s42, v42
    v_mul_f32 v111, s42, v43
    v_exp_f32 v108, v108
    v_exp_f32 v109, v109
    v_exp_f32 v110, v110
    v_exp_f32 v111, v111
    v_add_f32 v108, 1.0, v108
    v_add_f32 v109, 1.0, v109
    v_add_f32 v110, 1.0, v110
    v_add_f32 v111, 1.0, v111
    v_rcp_f32 v108, v108
    v_rcp_f32 v109, v109
    v_rcp_f32 v110, v110
    v_rcp_f32 v111, v111
    v_mul_f32 v44, v44, v108
    v_mul_f32 v45, v45, v109
    v_mul_f32 v46, v46, v110
    v_mul_f32 v47, v47, v111
    v_mul_f32 v48, v48, v108
    v_mul_f32 v49, v49, v109
    v_mul_f32 v50, v50, v110
    v_mul_f32 v51, v51, v111
    v_mul_f32 v52, v52, v108
    v_mul_f32 v53, v53, v109
    v_mul_f32 v54, v54, v110
    v_mul_f32 v55, v55, v111
    v_cvt_pk_bf16_f32 v112, v40, v41
    v_cvt_pk_bf16_f32 v113, v42, v43
    v_cvt_pk_bf16_f32 v114, v44, v45
    v_cvt_pk_bf16_f32 v115, v46, v47
    v_cvt_pk_bf16_f32 v116, v48, v49
    v_cvt_pk_bf16_f32 v117, v50, v51
    v_cvt_pk_bf16_f32 v118, v52, v53
    v_cvt_pk_bf16_f32 v119, v54, v55
    ds_write_b64 v0, v[112:113] offset:0
    ds_write_b64 v0, v[114:115] offset:128
    ds_write_b64 v0, v[116:117] offset:256
    ds_write_b64 v0, v[118:119] offset:384
    s_mov_b64 exec, 1
    ds_add_u32 v5, v6 offset:880
    s_mov_b64 exec, -1
    s_mov_b32 s43, 0
L_spow0:
    ds_read_b32 v7, v5 offset:880
    s_waitcnt lgkmcnt(0)
    v_readfirstlane_b32 s42, v7
    s_add_u32 s43, s43, 1
    s_cmp_ge_u32 s42, 4
    s_cbranch_scc1 L_spow0_ok
    s_cmp_lt_u32 s43, 0x400000
    s_cbranch_scc1 L_spow0
L_spow0_ok:
    ds_read_b128 v[112:115], v1
    ds_read_b128 v[116:119], v2 offset:1024
    s_mov_b32 s42, 0
    s_waitcnt lgkmcnt(1)
    buffer_store_dwordx4 v[112:115], v3, s[12:15], s42 offen sc1
    s_mov_b32 s42, 1024
    s_waitcnt lgkmcnt(0)
    buffer_store_dwordx4 v[116:119], v3, s[12:15], s42 offen sc1
    s_mov_b64 exec, 1
    ds_add_u32 v5, v6 offset:896
    s_mov_b64 exec, -1
L2_nofin0:
    s_cmp_eq_u32 s24, 0
    s_cbranch_scc1 L2_nopre3
    s_mov_b32 s43, 0
L_spor3:
    ds_read_b32 v7, v5 offset:896
    s_waitcnt lgkmcnt(0)
    v_readfirstlane_b32 s42, v7
    s_add_u32 s43, s43, 1
    s_cmp_ge_u32 s42, 4
    s_cbranch_scc1 L_spor3_ok
    s_cmp_lt_u32 s43, 0x400000
    s_cbranch_scc1 L_spor3
L_spor3_ok:
L2_nopre3:
    v_mov_b32 v108, 0
    s_mov_b32 s43, 0
L_spt13:
    ds_read_b32 v109, v108 offset:812
    s_waitcnt lgkmcnt(0)
    v_readfirstlane_b32 s42, v109
    s_add_u32 s43, s43, 1
    s_cmp_ge_u32 s42, 2
    s_cbranch_scc1 L_spt13_ok
    s_sleep 12
    s_cmp_lt_u32 s43, 0x400000
    s_cbranch_scc1 L_spt13
L_spt13_ok:
    ds_read_b128 v[108:111], v104 offset:49152
    ds_read_b128 v[112:115], v105 offset:49152
    ds_read_b128 v[116:119], v106 offset:49152
    ds_read_b128 v[120:123], v107 offset:49152
    s_waitcnt lgkmcnt(3)
    v_mfma_f32_16x16x32_bf16 v[96:99], v[24:27], v[108:111], v[96:99]
    ds_read_b128 v[108:111], v104 offset:49408
    s_waitcnt lgkmcnt(3)
    v_mfma_f32_16x16x32_bf16 v[96:99], v[28:31], v[112:115], v[96:99]
    ds_read_b128 v[112:115], v105 offset:49408
    s_waitcnt lgkmcnt(3)
    v_mfma_f32_16x16x32_bf16 v[100:103], v[24:27], v[116:119], v[100:103]
    ds_read_b128 v[116:119], v106 offset:49408
    s_waitcnt lgkmcnt(3)
    v_mfma_f32_16x16x32_bf16 v[100:103], v[28:31], v[120:123], v[100:103]
    ds_read_b128 v[120:123], v107 offset:49408
    s_waitcnt lgkmcnt(3)
    v_mfma_f32_16x16x32_bf16 v[100:103], v[32:35], v[108:111], v[100:103]
    ds_read_b128 v[108:111], v104 offset:49664
    s_waitcnt lgkmcnt(3)
    v_mfma_f32_16x16x32_bf16 v[100:103], v[36:39], v[112:115], v[100:103]
    ds_read_b128 v[112:115], v105 offset:49664
    s_waitcnt lgkmcnt(3)
    v_mfma_f32_16x16x32_bf16 v[96:99], v[32:35], v[116:119], v[96:99]
    ds_read_b128 v[116:119], v106 offset:49664
    s_waitcnt lgkmcnt(3)
    v_mfma_f32_16x16x32_bf16 v[96:99], v[36:39], v[120:123], v[96:99]
    ds_read_b128 v[120:123], v107 offset:49664
    s_waitcnt lgkmcnt(3)
    v_mfma_f32_16x16x32_bf16 v[88:91], v[8:11], v[108:111], v[88:91]
    ds_read_b128 v[108:111], v104 offset:49920
    s_waitcnt lgkmcnt(3)
    v_mfma_f32_16x16x32_bf16 v[88:91], v[12:15], v[112:115], v[88:91]
    ds_read_b128 v[112:115], v105 offset:49920
    s_waitcnt lgkmcnt(3)
    v_mfma_f32_16x16x32_bf16 v[92:95], v[32:35], v[116:119], v[92:95]
    ds_read_b128 v[116:119], v106 offset:49920
    s_waitcnt lgkmcnt(3)
    v_mfma_f32_16x16x32_bf16 v[92:95], v[36:39], v[120:123], v[92:95]
    ds_read_b128 v[120:123], v107 offset:49920
    s_waitcnt lgkmcnt(3)
    v_mfma_f32_16x16x32_bf16 v[92:95], v[32:35], v[108:111], v[92:95]
    s_waitcnt lgkmcnt(2)
    v_mfma_f32_16x16x32_bf16 v[92:95], v[36:39], v[112:115], v[92:95]
    s_waitcnt lgkmcnt(1)
    v_mfma_f32_16x16x32_bf16 v[88:91], v[8:11], v[116:119], v[88:91]
    s_waitcnt lgkmcnt(0)
    v_mfma_f32_16x16x32_bf16 v[88:91], v[12:15], v[120:123], v[88:91]
    s_cmp_eq_u32 s24, 0
    s_nop 6
    s_cbranch_scc1 L2_nofin3
    s_mov_b32 s42, 0xbfb8aa3b
    v_mul_f32 v108, s42, v88
    v_mul_f32 v109, s42, v89
    v_mul_f32 v110, s42, v90
    v_mul_f32 v111, s42, v91
    v_exp_f32 v108, v108
    v_exp_f32 v109, v109
    v_exp_f32 v110, v110
    v_exp_f32 v111, v111
    v_add_f32 v108, 1.0, v108
    v_add_f32 v109, 1.0, v109
    v_add_f32 v110, 1.0, v110
    v_add_f32 v111, 1.0, v111
    v_rcp_f32 v108, v108
    v_rcp_f32 v109, v109
    v_rcp_f32 v110, v110
    v_rcp_f32 v111, v111
    v_mul_f32 v92, v92, v108
    v_mul_f32 v93, v93, v109
    v_mul_f32 v94, v94, v110
    v_mul_f32 v95, v95, v111
    v_mul_f32 v96, v96, v108
    v_mul_f32 v97, v97, v109
    v_mul_f32 v98, v98, v110
    v_mul_f32 v99, v99, v111
    v_mul_f32 v100, v100, v108
    v_mul_f32 v101, v101, v109
    v_mul_f32 v102, v102, v110
    v_mul_f32 v103, v103, v111
    v_cvt_pk_bf16_f32 v112, v88, v89
    v_cvt_pk_bf16_f32 v113, v90, v91
    v_cvt_pk_bf16_f32 v114, v92, v93
    v_cvt_pk_bf16_f32 v115, v94, v95
    v_cvt_pk_bf16_f32 v116, v96, v97
    v_cvt_pk_bf16_f32 v117, v98, v99
    v_cvt_pk_bf16_f32 v118, v100, v101
    v_cvt_pk_bf16_f32 v119, v102, v103
    ds_write_b64 v0, v[112:113] offset:0
    ds_write_b64 v0, v[114:115] offset:128
    ds_write_b64 v0, v[116:117] offset:256
    ds_write_b64 v0, v[118:119] offset:384
    s_mov_b64 exec, 1
    ds_add_u32 v5, v6 offset:892
    s_mov_b64 exec, -1
    s_mov_b32 s43, 0
L_spow3:
    ds_read_b32 v7, v5 offset:892
    s_waitcnt lgkmcnt(0)
    v_readfirstlane_b32 s42, v7
    s_add_u32 s43, s43, 1
    s_cmp_ge_u32 s42, 4
    s_cbranch_scc1 L_spow3_ok
    s_cmp_lt_u32 s43, 0x400000
    s_cbranch_scc1 L_spow3
L_spow3_ok:
    ds_read_b128 v[112:115], v1
    ds_read_b128 v[116:119], v2 offset:1024
    s_mov_b32 s42, 3211776
    s_sub_u32 s43, s41, 23
    v_cmp_gt_i32 vcc, s43, v4
    s_nop 0
    s_mov_b64 exec, vcc
    s_waitcnt lgkmcnt(1)
    s_cbranch_execz L2_wo30
    buffer_store_dwordx4 v[112:115], v3, s[12:15], s42 offen sc1
L2_wo30:
    s_mov_b64 exec, -1
    s_mov_b32 s42, 3212800
    s_sub_u32 s43, s41, 25
    v_cmp_gt_i32 vcc, s43, v4
    s_nop 0
    s_mov_b64 exec, vcc
    s_waitcnt lgkmcnt(0)
    s_cbranch_execz L2_wo31
    buffer_store_dwordx4 v[116:119], v3, s[12:15], s42 offen sc1
L2_wo31:
    s_mov_b64 exec, -1
    s_mov_b64 exec, 1
    ds_add_u32 v5, v6 offset:908
    s_mov_b64 exec, -1
L2_nofin3:
    s_cmp_eq_u32 s24, 0
    s_cbranch_scc1 L2_nopre1
    s_mov_b32 s43, 0
L_spor1:
    ds_read_b32 v7, v5 offset:908
    s_waitcnt lgkmcnt(0)
    v_readfirstlane_b32 s42, v7
    s_add_u32 s43, s43, 1
    s_cmp_ge_u32 s42, 4
    s_cbranch_scc1 L_spor1_ok
    s_cmp_lt_u32 s43, 0x400000
    s_cbranch_scc1 L_spor1
L_spor1_ok:
L2_nopre1:
    v_mov_b32 v108, 0
    s_mov_b32 s43, 0
L_spt11:
    ds_read_b32 v109, v108 offset:804
    s_waitcnt lgkmcnt(0)
    v_readfirstlane_b32 s42, v109
    s_add_u32 s43, s43, 1
    s_cmp_ge_u32 s42, 16
    s_cbranch_scc1 L_spt11_ok
    s_sleep 12
    s_cmp_lt_u32 s43, 0x400000
    s_cbranch_scc1 L_spt11
L_spt11_ok:
    ds_read_b128 v[108:111], v104 offset:16384
    ds_read_b128 v[112:115], v105 offset:16384
    ds_read_b128 v[116:119], v106 offset:16384
    ds_read_b128 v[120:123], v107 offset:16384
    s_waitcnt lgkmcnt(3)
    v_mfma_f32_16x16x32_bf16 v[64:67], v[24:27], v[108:111], v[64:67]
    ds_read_b128 v[108:111], v104 offset:16640
    s_waitcnt lgkmcnt(3)
    v_mfma_f32_16x16x32_bf16 v[64:67], v[28:31], v[112:115], v[64:67]
    ds_read_b128 v[112:115], v105 offset:16640
    s_waitcnt lgkmcnt(3)
    v_mfma_f32_16x16x32_bf16 v[68:71], v[24:27], v[116:119], v[68:71]
    ds_read_b128 v[116:119], v106 offset:16640
    s_waitcnt lgkmcnt(3)
    v_mfma_f32_16x16x32_bf16 v[68:71], v[28:31], v[120:123], v[68:71]
    ds_read_b128 v[120:123], v107 offset:16640
    s_waitcnt lgkmcnt(3)
    v_mfma_f32_16x16x32_bf16 v[68:71], v[32:35], v[108:111], v[68:71]
    ds_read_b128 v[108:111], v104 offset:16896
    s_waitcnt lgkmcnt(3)
    v_mfma_f32_16x16x32_bf16 v[68:71], v[36:39], v[112:115], v[68:71]
    ds_read_b128 v[112:115], v105 offset:16896
    s_waitcnt lgkmcnt(3)
    v_mfma_f32_16x16x32_bf16 v[64:67], v[32:35], v[116:119], v[64:67]
    ds_read_b128 v[116:119], v106 offset:16896
    s_waitcnt lgkmcnt(3)
    v_mfma_f32_16x16x32_bf16 v[64:67], v[36:39], v[120:123], v[64:67]
    ds_read_b128 v[120:123], v107 offset:16896
    s_waitcnt lgkmcnt(3)
    v_mfma_f32_16x16x32_bf16 v[56:59], v[8:11], v[108:111], v[56:59]
    ds_read_b128 v[108:111], v104 offset:17152
    s_waitcnt lgkmcnt(3)
    v_mfma_f32_16x16x32_bf16 v[56:59], v[12:15], v[112:115], v[56:59]
    ds_read_b128 v[112:115], v105 offset:17152
    s_waitcnt lgkmcnt(3)
    v_mfma_f32_16x16x32_bf16 v[60:63], v[32:35], v[116:119], v[60:63]
    ds_read_b128 v[116:119], v106 offset:17152
    s_waitcnt lgkmcnt(3)
    v_mfma_f32_16x16x32_bf16 v[60:63], v[36:39], v[120:123], v[60:63]
    ds_read_b128 v[120:123], v107 offset:17152
    s_waitcnt lgkmcnt(3)
    v_mfma_f32_16x16x32_bf16 v[60:63], v[32:35], v[108:111], v[60:63]
    s_waitcnt lgkmcnt(2)
    v_mfma_f32_16x16x32_bf16 v[60:63], v[36:39], v[112:115], v[60:63]
    s_waitcnt lgkmcnt(1)
    v_mfma_f32_16x16x32_bf16 v[56:59], v[8:11], v[116:119], v[56:59]
    s_waitcnt lgkmcnt(0)
    v_mfma_f32_16x16x32_bf16 v[56:59], v[12:15], v[120:123], v[56:59]
    s_cmp_eq_u32 s24, 0
    s_nop 6
    s_cbranch_scc1 L2_nofin1
    s_mov_b32 s42, 0xbfb8aa3b
    v_mul_f32 v108, s42, v56
    v_mul_f32 v109, s42, v57
    v_mul_f32 v110, s42, v58
    v_mul_f32 v111, s42, v59
    v_exp_f32 v108, v108
    v_exp_f32 v109, v109
    v_exp_f32 v110, v110
    v_exp_f32 v111, v111
    v_add_f32 v108, 1.0, v108
    v_add_f32 v109, 1.0, v109
    v_add_f32 v110, 1.0, v110
    v_add_f32 v111, 1.0, v111
    v_rcp_f32 v108, v108
    v_rcp_f32 v109, v109
    v_rcp_f32 v110, v110
    v_rcp_f32 v111, v111
    v_mul_f32 v60, v60, v108
    v_mul_f32 v61, v61, v109
    v_mul_f32 v62, v62, v110
    v_mul_f32 v63, v63, v111
    v_mul_f32 v64, v64, v108
    v_mul_f32 v65, v65, v109
    v_mul_f32 v66, v66, v110
    v_mul_f32 v67, v67, v111
    v_mul_f32 v68, v68, v108
    v_mul_f32 v69, v69, v109
    v_mul_f32 v70, v70, v110
    v_mul_f32 v71, v71, v111
    v_cvt_pk_bf16_f32 v112, v56, v57
    v_cvt_pk_bf16_f32 v113, v58, v59
    v_cvt_pk_bf16_f32 v114, v60, v61
    v_cvt_pk_bf16_f32 v115, v62, v63
    v_cvt_pk_bf16_f32 v116, v64, v65
    v_cvt_pk_bf16_f32 v117, v66, v67
    v_cvt_pk_bf16_f32 v118, v68, v69
    v_cvt_pk_bf16_f32 v119, v70, v71
    ds_write_b64 v0, v[112:113] offset:0
    ds_write_b64 v0, v[114:115] offset:128
    ds_write_b64 v0, v[116:117] offset:256
    ds_write_b64 v0, v[118:119] offset:384
    s_mov_b64 exec, 1
    ds_add_u32 v5, v6 offset:884
    s_mov_b64 exec, -1
    s_mov_b32 s43, 0
L_spow1:
    ds_read_b32 v7, v5 offset:884
    s_waitcnt lgkmcnt(0)
    v_readfirstlane_b32 s42, v7
    s_add_u32 s43, s43, 1
    s_cmp_ge_u32 s42, 4
    s_cbranch_scc1 L_spow1_ok
    s_cmp_lt_u32 s43, 0x400000
    s_cbranch_scc1 L_spow1
L_spow1_ok:
    ds_read_b128 v[112:115], v1
    ds_read_b128 v[116:119], v2 offset:1024
    s_mov_b32 s42, 8192
    v_cmp_le_u32 vcc, 9, v4
    v_add_u32 v123, 3187200, v3
    s_sub_u32 s43, s41, 16
    v_cndmask_b32 v122, v3, v123, vcc
    v_cmp_gt_i32 s[44:45], s43, v4
    s_nop 0
    s_or_b64 exec, vcc, s[44:45]
    s_waitcnt lgkmcnt(1)
    buffer_store_dwordx4 v[112:115], v122, s[12:15], s42 offen sc1
    s_mov_b64 exec, -1
    s_mov_b32 s42, 9216
    v_cmp_le_u32 vcc, 7, v4
    v_add_u32 v123, 3187200, v3
    s_sub_u32 s43, s41, 18
    v_cndmask_b32 v122, v3, v123, vcc
    v_cmp_gt_i32 s[44:45], s43, v4
    s_nop 0
    s_or_b64 exec, vcc, s[44:45]
    s_waitcnt lgkmcnt(0)
    buffer_store_dwordx4 v[116:119], v122, s[12:15], s42 offen sc1
    s_mov_b64 exec, -1
    s_mov_b64 exec, 1
    ds_add_u32 v5, v6 offset:900
    s_mov_b64 exec, -1
L2_nofin1:
    s_cmp_eq_u32 s24, 0
    s_cbranch_scc1 L2_nopre2
    s_mov_b32 s43, 0
L_spor2:
    ds_read_b32 v7, v5 offset:900
    s_waitcnt lgkmcnt(0)
    v_readfirstlane_b32 s42, v7
    s_add_u32 s43, s43, 1
    s_cmp_ge_u32 s42, 4
    s_cbranch_scc1 L_spor2_ok
    s_cmp_lt_u32 s43, 0x400000
    s_cbranch_scc1 L_spor2
L_spor2_ok:
L2_nopre2:
    v_mov_b32 v108, 0
    s_mov_b32 s43, 0
L_spt12:
    ds_read_b32 v109, v108 offset:808
    s_waitcnt lgkmcnt(0)
    v_readfirstlane_b32 s42, v109
    s_add_u32 s43, s43, 1
    s_cmp_ge_u32 s42, 16
    s_cbranch_scc1 L_spt12_ok
    s_sleep 1
    s_cmp_lt_u32 s43, 0x400000
    s_cbranch_scc1 L_spt12
L_spt12_ok:
    s_cmp_eq_u32 s24, 0
    s_cbranch_scc1 L2_lastslow
    ds_read_b128 v[108:111], v104 offset:32768
    ds_read_b128 v[112:115], v106 offset:32768
    ds_read_b128 v[116:119], v104 offset:33024
    ds_read_b128 v[120:123], v104 offset:33280
    ds_read_b128 v[40:43], v105 offset:32768
    ds_read_b128 v[44:47], v107 offset:32768
    ds_read_b128 v[48:51], v105 offset:33024
    ds_read_b128 v[52:55], v105 offset:33280
    ds_read_b128 v[56:59], v106 offset:33024
    ds_read_b128 v[60:63], v106 offset:33280
    ds_read_b128 v[64:67], v104 offset:33536
    ds_read_b128 v[68:71], v106 offset:33536
    ds_read_b128 v[88:91], v107 offset:33024
    ds_read_b128 v[92:95], v107 offset:33280
    ds_read_b128 v[96:99], v105 offset:33536
    ds_read_b128 v[100:103], v107 offset:33536
    s_waitcnt lgkmcnt(15)
    v_mfma_f32_16x16x32_bf16 v[80:83], v[24:27], v[108:111], v[80:83]
    s_waitcnt lgkmcnt(14)
    v_mfma_f32_16x16x32_bf16 v[84:87], v[24:27], v[112:115], v[84:87]
    s_waitcnt lgkmcnt(13)
    v_mfma_f32_16x16x32_bf16 v[84:87], v[32:35], v[116:119], v[84:87]
    s_waitcnt lgkmcnt(12)
    v_mfma_f32_16x16x32_bf16 v[72:75], v[8:11], v[120:123], v[72:75]
    s_waitcnt lgkmcnt(11)
    v_mfma_f32_16x16x32_bf16 v[80:83], v[28:31], v[40:43], v[80:83]
    s_waitcnt lgkmcnt(10)
    v_mfma_f32_16x16x32_bf16 v[84:87], v[28:31], v[44:47], v[84:87]
    s_waitcnt lgkmcnt(9)
    v_mfma_f32_16x16x32_bf16 v[84:87], v[36:39], v[48:51], v[84:87]
    s_waitcnt lgkmcnt(8)
    v_mfma_f32_16x16x32_bf16 v[72:75], v[12:15], v[52:55], v[72:75]
    s_waitcnt lgkmcnt(7)
    v_mfma_f32_16x16x32_bf16 v[80:83], v[32:35], v[56:59], v[80:83]
    s_waitcnt lgkmcnt(6)
    v_mfma_f32_16x16x32_bf16 v[76:79], v[32:35], v[60:63], v[76:79]
    s_waitcnt lgkmcnt(5)
    v_mfma_f32_16x16x32_bf16 v[76:79], v[32:35], v[64:67], v[76:79]
    s_waitcnt lgkmcnt(4)
    v_mfma_f32_16x16x32_bf16 v[72:75], v[8:11], v[68:71], v[72:75]
    s_waitcnt lgkmcnt(3)
    v_mfma_f32_16x16x32_bf16 v[80:83], v[36:39], v[88:91], v[80:83]
    s_waitcnt lgkmcnt(2)
    v_mfma_f32_16x16x32_bf16 v[76:79], v[36:39], v[92:95], v[76:79]
    s_waitcnt lgkmcnt(1)
    v_mfma_f32_16x16x32_bf16 v[76:79], v[36:39], v[96:99], v[76:79]
    s_waitcnt lgkmcnt(0)
    v_mfma_f32_16x16x32_bf16 v[72:75], v[12:15], v[100:103], v[72:75]
    s_branch L2_lastdone
L2_lastslow:
    ds_read_b128 v[108:111], v104 offset:32768
    ds_read_b128 v[112:115], v105 offset:32768
    ds_read_b128 v[116:119], v106 offset:32768
    ds_read_b128 v[120:123], v107 offset:32768
    s_waitcnt lgkmcnt(3)
    v_mfma_f32_16x16x32_bf16 v[80:83], v[24:27], v[108:111], v[80:83]
    ds_read_b128 v[108:111], v104 offset:33024
    s_waitcnt lgkmcnt(3)
    v_mfma_f32_16x16x32_bf16 v[80:83], v[28:31], v[112:115], v[80:83]
    ds_read_b128 v[112:115], v105 offset:33024
    s_waitcnt lgkmcnt(3)
    v_mfma_f32_16x16x32_bf16 v[84:87], v[24:27], v[116:119], v[84:87]
    ds_read_b128 v[116:119], v106 offset:33024
    s_waitcnt lgkmcnt(3)
    v_mfma_f32_16x16x32_bf16 v[84:87], v[28:31], v[120:123], v[84:87]
    ds_read_b128 v[120:123], v107 offset:33024
    s_waitcnt lgkmcnt(3)
    v_mfma_f32_16x16x32_bf16 v[84:87], v[32:35], v[108:111], v[84:87]
    ds_read_b128 v[108:111], v104 offset:33280
    s_waitcnt lgkmcnt(3)
    v_mfma_f32_16x16x32_bf16 v[84:87], v[36:39], v[112:115], v[84:87]
    ds_read_b128 v[112:115], v105 offset:33280
    s_waitcnt lgkmcnt(3)
    v_mfma_f32_16x16x32_bf16 v[80:83], v[32:35], v[116:119], v[80:83]
    ds_read_b128 v[116:119], v106 offset:33280
    s_waitcnt lgkmcnt(3)
    v_mfma_f32_16x16x32_bf16 v[80:83], v[36:39], v[120:123], v[80:83]
    ds_read_b128 v[120:123], v107 offset:33280
    s_waitcnt lgkmcnt(3)
    v_mfma_f32_16x16x32_bf16 v[72:75], v[8:11], v[108:111], v[72:75]
    ds_read_b128 v[108:111], v104 offset:33536
    s_waitcnt lgkmcnt(3)
    v_mfma_f32_16x16x32_bf16 v[72:75], v[12:15], v[112:115], v[72:75]
    ds_read_b128 v[112:115], v105 offset:33536
    s_waitcnt lgkmcnt(3)
    v_mfma_f32_16x16x32_bf16 v[76:79], v[32:35], v[116:119], v[76:79]
    ds_read_b128 v[116:119], v106 offset:33536
    s_waitcnt lgkmcnt(3)
    v_mfma_f32_16x16x32_bf16 v[76:79], v[36:39], v[120:123], v[76:79]
    ds_read_b128 v[120:123], v107 offset:33536
    s_waitcnt lgkmcnt(3)
    v_mfma_f32_16x16x32_bf16 v[76:79], v[32:35], v[108:111], v[76:79]
    s_waitcnt lgkmcnt(2)
    v_mfma_f32_16x16x32_bf16 v[76:79], v[36:39], v[112:115], v[76:79]
    s_waitcnt lgkmcnt(1)
    v_mfma_f32_16x16x32_bf16 v[72:75], v[8:11], v[116:119], v[72:75]
    s_waitcnt lgkmcnt(0)
    v_mfma_f32_16x16x32_bf16 v[72:75], v[12:15], v[120:123], v[72:75]
L2_lastdone:
    s_cmp_eq_u32 s24, 0
    s_nop 6
    s_cbranch_scc1 L2_nofin2
    s_mov_b32 s42, 0xbfb8aa3b
    v_mul_f32 v108, s42, v72
    v_mul_f32 v109, s42, v73
    v_mul_f32 v110, s42, v74
    v_mul_f32 v111, s42, v75
    v_exp_f32 v108, v108
    v_exp_f32 v109, v109
    v_exp_f32 v110, v110
    v_exp_f32 v111, v111
    v_add_f32 v108, 1.0, v108
    v_add_f32 v109, 1.0, v109
    v_add_f32 v110, 1.0, v110
    v_add_f32 v111, 1.0, v111
    v_rcp_f32 v108, v108
    v_rcp_f32 v109, v109
    v_rcp_f32 v110, v110
    v_rcp_f32 v111, v111
    v_mul_f32 v76, v76, v108
    v_mul_f32 v77, v77, v109
    v_mul_f32 v78, v78, v110
    v_mul_f32 v79, v79, v111
    v_mul_f32 v80, v80, v108
    v_mul_f32 v81, v81, v109
    v_mul_f32 v82, v82, v110
    v_mul_f32 v83, v83, v111
    v_mul_f32 v84, v84, v108
    v_mul_f32 v85, v85, v109
    v_mul_f32 v86, v86, v110
    v_mul_f32 v87, v87, v111
    v_cvt_pk_bf16_f32 v112, v72, v73
    v_cvt_pk_bf16_f32 v113, v74, v75
    v_cvt_pk_bf16_f32 v114, v76, v77
    v_cvt_pk_bf16_f32 v115, v78, v79
    v_cvt_pk_bf16_f32 v116, v80, v81
    v_cvt_pk_bf16_f32 v117, v82, v83
    v_cvt_pk_bf16_f32 v118, v84, v85
    v_cvt_pk_bf16_f32 v119, v86, v87
    ds_write_b64 v0, v[112:113] offset:0
    ds_write_b64 v0, v[114:115] offset:128
    ds_write_b64 v0, v[116:117] offset:256
    ds_write_b64 v0, v[118:119] offset:384
    s_mov_b64 exec, 1
    ds_add_u32 v5, v6 offset:888
    s_mov_b64 exec, -1
    s_mov_b32 s43, 0
L_spow2:
    ds_read_b32 v7, v5 offset:888
    s_waitcnt lgkmcnt(0)
    v_readfirstlane_b32 s42, v7
    s_add_u32 s43, s43, 1
    s_cmp_ge_u32 s42, 4
    s_cbranch_scc1 L_spow2_ok
    s_cmp_lt_u32 s43, 0x400000
    s_cbranch_scc1 L_spow2
L_spow2_ok:
    ds_read_b128 v[112:115], v1
    ds_read_b128 v[116:119], v2 offset:1024
    s_mov_b32 s42, 3203584
    s_waitcnt lgkmcnt(1)
    buffer_store_dwordx4 v[112:115], v3, s[12:15], s42 offen sc1
    s_mov_b32 s42, 3204608
    s_waitcnt lgkmcnt(0)
    buffer_store_dwordx4 v[116:119], v3, s[12:15], s42 offen sc1
L2_nofin2:
    s_cmp_lg_u32 s24, 0
    s_cbranch_scc1 L2_m_exit
    s_add_u32 s89, s89, 1
    s_branch L2_m_slow
L2_m_overflow:
    s_mov_b32 s89, 0
    s_mov_b32 s23, 1
    s_waitcnt vmcnt(0)
    v_mov_b32 v40, 0
    v_mov_b32 v41, 0
    v_mov_b32 v42, 0
    v_mov_b32 v43, 0
    v_mov_b32 v44, 0
    v_mov_b32 v45, 0
    v_mov_b32 v46, 0
    v_mov_b32 v47, 0
    v_mov_b32 v48, 0
    v_mov_b32 v49, 0
    v_mov_b32 v50, 0
    v_mov_b32 v51, 0
    v_mov_b32 v52, 0
    v_mov_b32 v53, 0
    v_mov_b32 v54, 0
    v_mov_b32 v55, 0
    v_mov_b32 v56, 0
    v_mov_b32 v57, 0
    v_mov_b32 v58, 0
    v_mov_b32 v59, 0
    v_mov_b32 v60, 0
    v_mov_b32 v61, 0
    v_mov_b32 v62, 0
    v_mov_b32 v63, 0
    v_mov_b32 v64, 0
    v_mov_b32 v65, 0
    v_mov_b32 v66, 0
    v_mov_b32 v67, 0
    v_mov_b32 v68, 0
    v_mov_b32 v69, 0
    v_mov_b32 v70, 0
    v_mov_b32 v71, 0
    v_mov_b32 v72, 0
    v_mov_b32 v73, 0
    v_mov_b32 v74, 0
    v_mov_b32 v75, 0
    v_mov_b32 v76, 0
    v_mov_b32 v77, 0
    v_mov_b32 v78, 0
    v_mov_b32 v79, 0
    v_mov_b32 v80, 0
    v_mov_b32 v81, 0
    v_mov_b32 v82, 0
    v_mov_b32 v83, 0
    v_mov_b32 v84, 0
    v_mov_b32 v85, 0
    v_mov_b32 v86, 0
    v_mov_b32 v87, 0
    v_mov_b32 v88, 0
    v_mov_b32 v89, 0
    v_mov_b32 v90, 0
    v_mov_b32 v91, 0
    v_mov_b32 v92, 0
    v_mov_b32 v93, 0
    v_mov_b32 v94, 0
    v_mov_b32 v95, 0
    v_mov_b32 v96, 0
    v_mov_b32 v97, 0
    v_mov_b32 v98, 0
    v_mov_b32 v99, 0
    v_mov_b32 v100, 0
    v_mov_b32 v101, 0
    v_mov_b32 v102, 0
    v_mov_b32 v103, 0
L2_m_slow:
    s_waitcnt vmcnt(0) lgkmcnt(0)
    s_barrier
    s_cmp_eq_u32 s89, 499
    s_cselect_b32 s24, 1, 0
    s_cmp_lg_u32 s21, 1
    s_cbranch_scc1 L2_m_nz
    v_mov_b32 v108, 0
    v_mov_b32 v109, 0
    v_mov_b32 v110, 0
    v_mov_b32 v111, 0
    v_lshlrev_b32 v112, 2, v124
    ds_write_b128 v112, v[108:111]
    s_waitcnt lgkmcnt(0)
L2_m_nz:
    s_barrier
    s_branch L2_m_round
L2_m_exit:
L_end:
    s_endpgm
L_codeend:
.section .rodata,"a"
.p2align 6
.amdhsa_kernel gather_scatter__tensor_product_equiv_equiformer__graph_kernel
  .amdhsa_next_free_vgpr 128
  .amdhsa_next_free_sgpr 96
  .amdhsa_accum_offset 128
  .amdhsa_group_segment_fixed_size 0
  .amdhsa_kernarg_size 96
  .amdhsa_user_sgpr_count 2
  .amdhsa_user_sgpr_kernarg_segment_ptr 1
  .amdhsa_system_sgpr_workgroup_id_x 1
  .amdhsa_float_denorm_mode_32 3
.end_amdhsa_kernel
```
